```python
import torch

def _softmax(x, axis=-1):
    return torch.softmax(x, dim=axis)
def _gelu(x):
    return torch.nn.functional.gelu(x, approximate="tanh")
def _silu(x):
    return torch.nn.functional.silu(x)
def _sigmoid(x):
    return torch.sigmoid(x)
def _layernorm(x, axis=-1, eps=1e-5):
    m = x.mean(dim=axis, keepdim=True)
    v = x.var(dim=axis, keepdim=True, unbiased=False)
    return (x - m) / torch.sqrt(v + eps)
def _scatter_add(tgt, idx, src, axis=0):
    return tgt.clone().index_add_(axis, idx, src)
def _segment_sum(src, seg, n):
    out = torch.zeros((n,) + src.shape[1:], dtype=src.dtype)
    return out.index_add_(0, seg, src)
def _pad(x, pw):
    flat = tuple(v for pair in reversed(pw) for v in pair)
    return torch.nn.functional.pad(x, flat)

kernel_name = 'gated_mix__compressed_kv_cla__dense_activation_squared_relu__decode'

def setup_inputs():

    _w = (lambda a: (lambda t: t.to(torch.bfloat16) if t.is_floating_point() else t)(torch.as_tensor(a)))
    def _A_setup():
        B, H, Sq, Sk, D, M = 2, 32, 1, 8192, 128, 576
        Dc = 4 * D
        return {
            "x": _w((lambda *s: torch.randn(*s, dtype=torch.bfloat16) * 0.05)(B, Sq, M)),
            "c_kv": _w((lambda *s: torch.randn(*s, dtype=torch.bfloat16) * 1.6)(B, Sk, Dc)),
            "w_q": _w((lambda *s: torch.randn(*s, dtype=torch.bfloat16) * 6.4)(M, H, D) * (M ** -0.5)),
            "w_uk": _w((lambda *s: torch.randn(*s, dtype=torch.bfloat16) * 6.4)(Dc, H, D) * (Dc ** -0.5)),
            "w_uv": _w((lambda *s: torch.randn(*s, dtype=torch.bfloat16) * 1.6)(Dc, H, D) * (Dc ** -0.5)),
            "w_o": _w((lambda *s: torch.randn(*s, dtype=torch.bfloat16) * 1.6)(H, D, M) * ((H * D) ** -0.5)),
        }
    _A_in = _A_setup()

    def _B_setup():
        B, S, D, F = 2, 1, 576, 4608
        return {
            "x": _w((lambda *s: torch.randn(*s, dtype=torch.bfloat16) * 0.05)(B, S, D)),
            "w1": _w((lambda *s: torch.randn(*s, dtype=torch.bfloat16) * 0.4)(D, F)),
            "b1": _w((lambda *s: torch.randn(*s, dtype=torch.bfloat16) * 0.2)(F)),
            "w2": _w((lambda *s: torch.randn(*s, dtype=torch.bfloat16) * 0.2)(F, D)),
            "b2": _w((lambda *s: torch.randn(*s, dtype=torch.bfloat16) * 0.2)(D)),
        }
    _B_in = _B_setup()

    return {
        "A_x": _A_in["x"],
        "A_c_kv": _A_in["c_kv"],
        "A_w_q": _A_in["w_q"],
        "A_w_uk": _A_in["w_uk"],
        "A_w_uv": _A_in["w_uv"],
        "A_w_o": _A_in["w_o"],
        "B_x": _B_in["x"],
        "B_w1": _B_in["w1"],
        "B_b1": _B_in["b1"],
        "B_w2": _B_in["w2"],
        "B_b2": _B_in["b2"],
        "gate_w": _w((lambda *s: torch.randn(*s, dtype=torch.bfloat16) * 0.05)(576) * 16.0),
    }

def reference(A_x, A_c_kv, A_w_q, A_w_uk, A_w_uv, A_w_o, B_x, B_w1, B_b1, B_w2, B_b2, gate_w):
    def _A_ref(x, c_kv, w_q, w_uk, w_uv, w_o):
        B, Sq, M = x.shape[0], x.shape[1], x.shape[2]
        Sk = c_kv.shape[1]
        H, D = w_q.shape[1], w_q.shape[2]
        q = torch.einsum("bqm,mhd->bhqd", x, w_q)
        k = torch.einsum("bkc,chd->bhkd", c_kv, w_uk)
        v = torch.einsum("bkc,chd->bhkd", c_kv, w_uv)
        scores = torch.einsum("bhqd,bhkd->bhqk", q, k) * (D ** -0.5)
        off = Sk - Sq
        qi = torch.arange(Sq)[:, None]
        kj = torch.arange(Sk)[None, :]
        cmask = kj <= (qi + off)
        scores = torch.where(cmask[None, None], scores, -1e9)
        p = _softmax(scores, axis=-1)
        ctx = torch.einsum("bhqk,bhkd->bhqd", p, v)
        return torch.einsum("bhqd,hdm->bqm", ctx, w_o)

    def _B_ref(x, w1, b1, w2, b2):
        h = torch.einsum("bsd,df->bsf", x, w1) + b1
        zero = torch.zeros_like(h)
        r = torch.where(h > zero, h, zero)
        h = r * r
        out = torch.einsum("bsf,fd->bsd", h, w2) + b2
        return out

    x = A_x
    g = _sigmoid((x * gate_w).sum(-1, keepdims=True))
    a = _A_ref(x, A_c_kv, A_w_q, A_w_uk, A_w_uv, A_w_o)
    b = _B_ref(x, B_w1, B_b1, B_w2, B_b2)
    return g * a + (1 - g) * b
```

```asm
; @launch grid=(256,1,1) block=(576,1,1) lds=163840
.amdgcn_target "amdgcn-amd-amdhsa--gfx950"
.text
.globl gated_mix__compressed_kv_cla__dense_activation_squared_relu__decode_kernel
.p2align 8
.type gated_mix__compressed_kv_cla__dense_activation_squared_relu__decode_kernel,@function
gated_mix__compressed_kv_cla__dense_activation_squared_relu__decode_kernel:
    s_cmp_ge_u32 s2, 256
    s_cbranch_scc1 k_end
    s_load_dwordx2 s[4:5], s[0:1], 0
    s_load_dwordx2 s[8:9], s[0:1], 8
    s_load_dwordx2 s[12:13], s[0:1], 16
    s_load_dwordx2 s[16:17], s[0:1], 24
    s_load_dwordx2 s[20:21], s[0:1], 32
    s_load_dwordx2 s[24:25], s[0:1], 40
    s_load_dwordx2 s[28:29], s[0:1], 56
    s_load_dwordx2 s[32:33], s[0:1], 64
    s_load_dwordx2 s[36:37], s[0:1], 72
    s_load_dwordx2 s[40:41], s[0:1], 80
    s_load_dwordx2 s[44:45], s[0:1], 88
    s_load_dwordx2 s[48:49], s[0:1], 96
    s_load_dwordx2 s[52:53], s[0:1], 104
    s_load_dwordx2 s[56:57], s[0:1], 112
    s_load_dwordx2 s[60:61], s[0:1], 112
    s_mov_b32 s6, 2304
    s_mov_b32 s7, 0x00020000
    s_mov_b32 s10, 16777216
    s_mov_b32 s11, 0x00020000
    s_mov_b32 s14, 4718592
    s_mov_b32 s15, 0x00020000
    s_mov_b32 s18, 4194304
    s_mov_b32 s19, 0x00020000
    s_mov_b32 s22, 4194304
    s_mov_b32 s23, 0x00020000
    s_mov_b32 s26, 4718592
    s_mov_b32 s27, 0x00020000
    s_mov_b32 s30, 5308416
    s_mov_b32 s31, 0x00020000
    s_mov_b32 s34, 9216
    s_mov_b32 s35, 0x00020000
    s_mov_b32 s38, 5308416
    s_mov_b32 s39, 0x00020000
    s_mov_b32 s42, 1152
    s_mov_b32 s43, 0x00020000
    s_mov_b32 s46, 1152
    s_mov_b32 s47, 0x00020000
    s_mov_b32 s50, 2304
    s_mov_b32 s51, 0x00020000
    s_mov_b32 s54, 256
    s_mov_b32 s55, 0x00020000
    s_mov_b32 s58, 268435456
    s_mov_b32 s59, 0x00020000
    s_mov_b32 s62, 331776
    s_mov_b32 s63, 0x00020000
    s_mov_b32 s69, 0x05040100
    s_mov_b32 s70, 0x07060302
    v_readfirstlane_b32 s64, v0
    s_lshr_b32 s64, s64, 6
    v_and_b32 v1, 63, v0
    s_waitcnt lgkmcnt(0)
    s_add_u32 s60, s60, 1048576
    s_addc_u32 s61, s61, 0
    s_cmp_ge_u32 s2, 128
    s_cbranch_scc1 role_b
    s_lshl_b32 s72, s64, 8
    s_add_u32 s72, s72, s2
    s_cmp_ge_u32 s72, 8
    s_cbranch_scc1 a_nonw
    s_memrealtime s[80:81]
    v_mov_b32 v14, 0
    v_mov_b32 v13, 0
    v_cmp_eq_u32 vcc, 0, v1
    s_waitcnt lgkmcnt(0)
    s_or_b32 s80, s80, 1
    v_mov_b32 v12, s80
    s_and_saveexec_b64 s[78:79], vcc
    buffer_atomic_cmpswap v[12:13], v14, s[52:55], 0 offen
    s_mov_b64 exec, s[78:79]
    a_nonw:
    s_and_b32 s65, s2, 7
    s_lshr_b32 s72, s2, 3
    s_and_b32 s72, s72, 3
    s_lshl_b32 s72, s72, 3
    s_add_u32 s65, s65, s72
    s_lshr_b32 s66, s2, 5
    s_mov_b32 s3, s2
    v_lshrrev_b32 v5, 4, v0
    v_and_b32 v6, 15, v0
    v_lshrrev_b32 v7, 4, v1
    v_mul_u32_u24 v10, 911, v0
    v_lshrrev_b32 v10, 16, v10
    v_mul_u32_u24 v11, 72, v10
    v_sub_u32 v11, v0, v11
    v_lshlrev_b32 v8, 13, v6
    v_lshl_add_u32 v8, v7, 4, v8
    s_lshl_b32 s72, s66, 7
    s_lshl_b32 s73, s64, 4
    s_add_u32 s72, s72, s73
    s_lshl_b32 s72, s72, 13
    s_lshl_b32 s73, s65, 8
    s_add_u32 s72, s72, s73
    s_mov_b32 s76, s72
    v_lshlrev_b32 v4, 3, v5
    s_mul_i32 s73, s66, 288
    v_lshlrev_b32 v3, 15, v5
    v_lshl_add_u32 v3, v6, 4, v3
    s_mul_i32 s72, s66, 1179648
    s_lshl_b32 s74, s65, 8
    s_add_u32 s72, s72, s74
    buffer_load_dwordx2 v[128:129], v4, s[4:7], s73 offen
    buffer_load_dwordx2 v[136:137], v4, s[4:7], s73 offen offset:1152
    buffer_load_dwordx4 v[64:67], v3, s[12:15], s72 offen nt
    s_add_u32 s72, s72, 8192
    buffer_load_dwordx4 v[68:71], v3, s[12:15], s72 offen nt
    s_add_u32 s72, s72, 8192
    buffer_load_dwordx4 v[72:75], v3, s[12:15], s72 offen nt
    s_add_u32 s72, s72, 8192
    buffer_load_dwordx4 v[76:79], v3, s[12:15], s72 offen nt
    v_mov_b32 v14, 0
    s_cmp_lg_u32 s64, 8
    s_cbranch_scc1 a0_non
    buffer_load_dword v13, v14, s[52:55], 0 offen sc1
    a0_non:
    s_lshl_b32 s68, s66, 2
    s_and_b32 s74, s64, 7
    s_lshr_b32 s73, s74, 1
    s_add_u32 s68, s68, s73
    s_lshl_b32 s68, s68, 1
    s_lshr_b32 s73, s65, 4
    s_add_u32 s68, s68, s73
    s_lshl_b32 s68, s68, 6
    s_and_b32 s73, s74, 1
    s_lshl_b32 s73, s73, 5
    s_add_u32 s68, s68, s73
    s_and_b32 s73, s65, 15
    s_add_u32 s68, s68, s73
    s_lshl_b32 s68, s68, 4
    v_lshlrev_b32 v9, 15, v6
    v_lshrrev_b32 v2, 1, v7
    v_lshl_add_u32 v9, v2, 8, v9
    v_and_b32 v2, 1, v7
    v_lshl_add_u32 v9, v2, 3, v9
    v_mov_b32 v144, 0
    v_mov_b32 v145, 0
    v_mov_b32 v146, 0
    v_mov_b32 v147, 0
    v_mov_b32 v148, 0
    v_mov_b32 v149, 0
    v_mov_b32 v150, 0
    v_mov_b32 v151, 0
    v_mov_b32 v152, 0
    v_mov_b32 v153, 0
    v_mov_b32 v154, 0
    v_mov_b32 v155, 0
    v_mov_b32 v156, 0
    v_mov_b32 v157, 0
    v_mov_b32 v158, 0
    v_mov_b32 v159, 0
    s_waitcnt vmcnt(2)
    v_perm_b32 v20, v68, v64, s69
    v_perm_b32 v21, v68, v64, s70
    v_dot2c_f32_bf16 v144, v20, v128
    v_dot2c_f32_bf16 v145, v21, v128
    v_dot2c_f32_bf16 v152, v20, v136
    v_dot2c_f32_bf16 v153, v21, v136
    v_perm_b32 v20, v69, v65, s69
    v_perm_b32 v21, v69, v65, s70
    v_dot2c_f32_bf16 v146, v20, v128
    v_dot2c_f32_bf16 v147, v21, v128
    v_dot2c_f32_bf16 v154, v20, v136
    v_dot2c_f32_bf16 v155, v21, v136
    v_perm_b32 v20, v70, v66, s69
    v_perm_b32 v21, v70, v66, s70
    v_dot2c_f32_bf16 v148, v20, v128
    v_dot2c_f32_bf16 v149, v21, v128
    v_dot2c_f32_bf16 v156, v20, v136
    v_dot2c_f32_bf16 v157, v21, v136
    v_perm_b32 v20, v71, v67, s69
    v_perm_b32 v21, v71, v67, s70
    v_dot2c_f32_bf16 v150, v20, v128
    v_dot2c_f32_bf16 v151, v21, v128
    v_dot2c_f32_bf16 v158, v20, v136
    v_dot2c_f32_bf16 v159, v21, v136
    s_waitcnt vmcnt(0)
    v_perm_b32 v20, v76, v72, s69
    v_perm_b32 v21, v76, v72, s70
    v_dot2c_f32_bf16 v144, v20, v129
    v_dot2c_f32_bf16 v145, v21, v129
    v_dot2c_f32_bf16 v152, v20, v137
    v_dot2c_f32_bf16 v153, v21, v137
    v_perm_b32 v20, v77, v73, s69
    v_perm_b32 v21, v77, v73, s70
    v_dot2c_f32_bf16 v146, v20, v129
    v_dot2c_f32_bf16 v147, v21, v129
    v_dot2c_f32_bf16 v154, v20, v137
    v_dot2c_f32_bf16 v155, v21, v137
    v_perm_b32 v20, v78, v74, s69
    v_perm_b32 v21, v78, v74, s70
    v_dot2c_f32_bf16 v148, v20, v129
    v_dot2c_f32_bf16 v149, v21, v129
    v_dot2c_f32_bf16 v156, v20, v137
    v_dot2c_f32_bf16 v157, v21, v137
    v_perm_b32 v20, v79, v75, s69
    v_perm_b32 v21, v79, v75, s70
    v_dot2c_f32_bf16 v150, v20, v129
    v_dot2c_f32_bf16 v151, v21, v129
    v_dot2c_f32_bf16 v158, v20, v137
    v_dot2c_f32_bf16 v159, v21, v137
    s_nop 3
    v_lshlrev_b32 v4, 10, v5
    v_lshl_add_u32 v4, v6, 5, v4
    ds_write_b128 v4, v[144:147] offset:2048
    ds_write_b128 v4, v[148:151] offset:2064
    ds_write_b128 v4, v[152:155] offset:2560
    ds_write_b128 v4, v[156:159] offset:2576
    s_cmp_lg_u32 s64, 8
    s_cbranch_scc1 a1_non
    s_mov_b32 s77, 0
    v_mov_b32 v14, 0
    s_branch nw_1_chk
nw_1_loop:
    buffer_load_dword v13, v14, s[52:55], 0 offen sc1
nw_1_chk:
    s_add_u32 s77, s77, 1
    s_waitcnt vmcnt(0)
    v_readfirstlane_b32 s71, v13
    s_cmp_ge_u32 s77, 200000
    s_cbranch_scc1 nw_1_done
    s_cmp_eq_u32 s71, 0
    s_cbranch_scc1 nw_1_loop
nw_1_done:
    ds_write_b32 v14, v13 offset:1024
a1_non:
    s_waitcnt lgkmcnt(0)
    s_barrier
    v_mov_b32 v14, 0
    ds_read_b32 v13, v14 offset:1024
    s_waitcnt lgkmcnt(0)
    v_readfirstlane_b32 s71, v13
    s_cmp_ge_u32 s64, 4
    s_cbranch_scc1 a1_skip_pub
    v_lshlrev_b32 v4, 2, v0
    ds_read_b32 v80, v4 offset:2048
    ds_read_b32 v81, v4 offset:3072
    ds_read_b32 v82, v4 offset:4096
    ds_read_b32 v83, v4 offset:5120
    ds_read_b32 v84, v4 offset:6144
    ds_read_b32 v85, v4 offset:7168
    ds_read_b32 v86, v4 offset:8192
    ds_read_b32 v87, v4 offset:9216
    ds_read_b32 v88, v4 offset:10240
    ds_read_b32 v89, v4 offset:11264
    ds_read_b32 v90, v4 offset:12288
    ds_read_b32 v91, v4 offset:13312
    ds_read_b32 v92, v4 offset:14336
    ds_read_b32 v93, v4 offset:15360
    ds_read_b32 v94, v4 offset:16384
    ds_read_b32 v95, v4 offset:17408
    ds_read_b32 v96, v4 offset:18432
    ds_read_b32 v97, v4 offset:19456
    ds_read_b32 v98, v4 offset:20480
    ds_read_b32 v99, v4 offset:21504
    ds_read_b32 v100, v4 offset:22528
    ds_read_b32 v101, v4 offset:23552
    ds_read_b32 v102, v4 offset:24576
    ds_read_b32 v103, v4 offset:25600
    ds_read_b32 v104, v4 offset:26624
    ds_read_b32 v105, v4 offset:27648
    ds_read_b32 v106, v4 offset:28672
    ds_read_b32 v107, v4 offset:29696
    ds_read_b32 v108, v4 offset:30720
    ds_read_b32 v109, v4 offset:31744
    ds_read_b32 v110, v4 offset:32768
    ds_read_b32 v111, v4 offset:33792
    ds_read_b32 v112, v4 offset:34816
    ds_read_b32 v113, v4 offset:35840
    ds_read_b32 v114, v4 offset:36864
    ds_read_b32 v115, v4 offset:37888
    s_waitcnt lgkmcnt(0)
    v_add_f32 v80, v80, v81
    v_add_f32 v82, v82, v83
    v_add_f32 v84, v84, v85
    v_add_f32 v86, v86, v87
    v_add_f32 v88, v88, v89
    v_add_f32 v90, v90, v91
    v_add_f32 v92, v92, v93
    v_add_f32 v94, v94, v95
    v_add_f32 v96, v96, v97
    v_add_f32 v98, v98, v99
    v_add_f32 v100, v100, v101
    v_add_f32 v102, v102, v103
    v_add_f32 v104, v104, v105
    v_add_f32 v106, v106, v107
    v_add_f32 v108, v108, v109
    v_add_f32 v110, v110, v111
    v_add_f32 v112, v112, v113
    v_add_f32 v114, v114, v115
    v_add_f32 v80, v80, v82
    v_add_f32 v84, v84, v86
    v_add_f32 v88, v88, v90
    v_add_f32 v92, v92, v94
    v_add_f32 v96, v96, v98
    v_add_f32 v100, v100, v102
    v_add_f32 v104, v104, v106
    v_add_f32 v108, v108, v110
    v_add_f32 v112, v112, v114
    v_add_f32 v80, v80, v84
    v_add_f32 v88, v88, v92
    v_add_f32 v96, v96, v100
    v_add_f32 v104, v104, v108
    v_add_f32 v80, v80, v88
    v_add_f32 v96, v96, v104
    v_add_f32 v80, v80, v96
    v_add_f32 v80, v80, v112
    v_mov_b32 v12, v80
    v_lshlrev_b32 v4, 3, v0
    s_lshl_b32 s72, s65, 13
    s_add_u32 s72, s72, 655360
    s_lshl_b32 s73, s66, 11
    s_add_u32 s73, s73, s72
    buffer_store_dwordx2 v[12:13], v4, s[56:59], s73 offen sc1
    s_mov_b32 s77, 0
a1_skip_pub:
    s_barrier
    s_cmp_ge_u32 s64, 8
    s_cbranch_scc1 a0_nowuk
    buffer_load_dwordx4 v[48:51], v8, s[16:19], s76 offen nt
    buffer_load_dwordx4 v[52:55], v8, s[16:19], s76 offen offset:64 nt
    buffer_load_dwordx4 v[56:59], v8, s[16:19], s76 offen offset:128 nt
    buffer_load_dwordx4 v[60:63], v8, s[16:19], s76 offen offset:192 nt
    a0_nowuk:
    s_cmp_ge_u32 s64, 4
    s_cbranch_scc1 a1_skip_red
qx_retry:
    buffer_load_dwordx2 v[16:17], v4, s[56:59], s72 offen sc1
    buffer_load_dwordx2 v[18:19], v4, s[56:59], s72 offen offset:2048 sc1
    s_add_u32 s73, s72, 4096
    buffer_load_dwordx2 v[20:21], v4, s[56:59], s73 offen sc1
    buffer_load_dwordx2 v[22:23], v4, s[56:59], s73 offen offset:2048 sc1
    s_waitcnt vmcnt(0)
    v_xor_b32 v17, v17, v13
    v_xor_b32 v19, v19, v13
    v_xor_b32 v21, v21, v13
    v_xor_b32 v23, v23, v13
    v_or3_b32 v17, v17, v19, v21
    v_or_b32 v17, v17, v23
    v_cmp_ne_u32 vcc, 0, v17
    s_add_u32 s77, s77, 1
    s_cmp_ge_u32 s77, 200000
    s_cbranch_scc1 qx_ok
    s_cbranch_vccnz qx_retry
qx_ok:
    v_add_f32 v16, v16, v18
    v_add_f32 v20, v20, v22
    v_add_f32 v16, v16, v20
    v_cvt_pk_bf16_f32 v16, v16, v16
    v_lshlrev_b32 v4, 1, v0
    ds_write_b16 v4, v16 offset:0
    s_waitcnt lgkmcnt(0)
a1_skip_red:
    s_barrier
    s_cmp_ge_u32 s64, 8
    s_cbranch_scc1 a1_done
    v_mov_b32 v16, 0
    v_mov_b32 v17, 0
    v_mov_b32 v18, 0
    v_mov_b32 v19, 0
    v_mov_b32 v20, 0
    v_mov_b32 v21, 0
    v_mov_b32 v22, 0
    v_mov_b32 v23, 0
    v_mov_b32 v24, 0
    v_mov_b32 v25, 0
    v_mov_b32 v26, 0
    v_mov_b32 v27, 0
    v_mov_b32 v28, 0
    v_mov_b32 v29, 0
    v_mov_b32 v30, 0
    v_mov_b32 v31, 0
    v_mov_b32 v32, 0
    v_mov_b32 v33, 0
    v_mov_b32 v34, 0
    v_mov_b32 v35, 0
    v_lshlrev_b32 v8, 8, v6
    v_lshl_add_u32 v8, v7, 4, v8
    v_cmp_gt_u32 vcc, 2, v6
    s_and_saveexec_b64 s[78:79], vcc
    ds_read_b128 v[16:19], v8 offset:0
    ds_read_b128 v[20:23], v8 offset:64
    ds_read_b128 v[24:27], v8 offset:128
    ds_read_b128 v[28:31], v8 offset:192
    s_mov_b64 exec, s[78:79]
    s_waitcnt vmcnt(0) lgkmcnt(0)
    s_nop 4
    v_mfma_f32_16x16x32_bf16 v[32:35], v[48:51], v[16:19], v[32:35]
    v_mfma_f32_16x16x32_bf16 v[32:35], v[52:55], v[20:23], v[32:35]
    v_mfma_f32_16x16x32_bf16 v[32:35], v[56:59], v[24:27], v[32:35]
    v_mfma_f32_16x16x32_bf16 v[32:35], v[60:63], v[28:31], v[32:35]
    s_nop 7
    s_nop 1
    v_cvt_pk_bf16_f32 v36, v32, v33
    v_cvt_pk_bf16_f32 v37, v34, v35
    v_lshlrev_b32 v9, 8, v6
    v_lshl_add_u32 v9, v7, 3, v9
    s_lshl_b32 s73, s64, 5
    v_add_u32 v9, s73, v9
    v_cmp_gt_u32 vcc, 2, v6
    s_and_saveexec_b64 s[78:79], vcc
    ds_write_b64 v9, v[36:37] offset:512
    s_mov_b64 exec, s[78:79]
    s_waitcnt lgkmcnt(0)
a1_done:
    s_barrier
    s_cmp_lg_u32 s64, 8
    s_cbranch_scc1 a1_nost
    v_and_b32 v2, 31, v1
    v_lshlrev_b32 v3, 4, v2
    ds_read_b128 v[16:19], v3 offset:512
    v_lshrrev_b32 v4, 4, v2
    v_lshlrev_b32 v4, 15, v4
    v_and_b32 v2, 15, v2
    v_lshl_add_u32 v4, v2, 4, v4
    s_lshl_b32 s72, s65, 10
    s_lshl_b32 s73, s66, 8
    s_add_u32 s72, s72, s73
    v_cmp_gt_u32 vcc, 32, v1
    s_and_saveexec_b64 s[78:79], vcc
    s_waitcnt lgkmcnt(0)
    buffer_store_dwordx4 v[16:19], v4, s[56:59], s72 offen sc1
    s_mov_b64 exec, s[78:79]
    s_waitcnt vmcnt(0)
    a1_nost:
    s_cmp_lg_u32 s64, 8
    s_cbranch_scc1 sig_2
    s_lshl_b32 s72, s3, 2
    s_add_u32 s72, s72, 983040
    v_mov_b32 v2, s71
    v_lshlrev_b32 v3, 10, v1
    v_cmp_gt_u32 vcc, 8, v1
    s_and_saveexec_b64 s[78:79], vcc
    buffer_store_dword v2, v3, s[56:59], s72 offen sc1
    s_mov_b64 exec, s[78:79]
sig_2:
    s_barrier
    s_cmp_ge_u32 s64, 8
    s_cbranch_scc1 a_nowuv
    v_lshlrev_b32 v8, 13, v7
    v_lshl_add_u32 v8, v6, 4, v8
    s_lshl_b32 s72, s66, 20
    s_lshl_b32 s73, s65, 8
    s_add_u32 s72, s72, s73
    s_lshl_b32 s73, s64, 17
    s_add_u32 s72, s72, s73
    s_lshl_b32 s73, s64, 12
    s_mov_b32 m0, s73
    s_add_u32 s73, s73, 1024
    buffer_load_dwordx4 v8, s[20:23], s72 offen nt lds
    s_add_u32 s72, s72, 32768
    s_mov_b32 m0, s73
    s_add_u32 s73, s73, 1024
    buffer_load_dwordx4 v8, s[20:23], s72 offen nt lds
    s_add_u32 s72, s72, 32768
    s_mov_b32 m0, s73
    s_add_u32 s73, s73, 1024
    buffer_load_dwordx4 v8, s[20:23], s72 offen nt lds
    s_add_u32 s72, s72, 32768
    s_mov_b32 m0, s73
    s_add_u32 s73, s73, 1024
    buffer_load_dwordx4 v8, s[20:23], s72 offen nt lds
    s_add_u32 s72, s72, 32768
a_nowuv:
    v_lshlrev_b32 v8, 4, v1
    s_mul_i32 s72, s65, 147456
    s_mul_i32 s73, s64, 12288
    s_add_u32 s73, s73, 36864
    s_add_u32 s72, s72, s73
    s_mov_b32 m0, s73
    s_add_u32 s73, s73, 1024
    buffer_load_dwordx4 v8, s[24:27], s72 offen nt lds
    s_add_u32 s72, s72, 1024
    s_mov_b32 m0, s73
    s_add_u32 s73, s73, 1024
    buffer_load_dwordx4 v8, s[24:27], s72 offen nt lds
    s_add_u32 s72, s72, 1024
    s_mov_b32 m0, s73
    s_add_u32 s73, s73, 1024
    buffer_load_dwordx4 v8, s[24:27], s72 offen nt lds
    s_add_u32 s72, s72, 1024
    s_mov_b32 m0, s73
    s_add_u32 s73, s73, 1024
    buffer_load_dwordx4 v8, s[24:27], s72 offen nt lds
    s_add_u32 s72, s72, 1024
    s_mov_b32 m0, s73
    s_add_u32 s73, s73, 1024
    buffer_load_dwordx4 v8, s[24:27], s72 offen nt lds
    s_add_u32 s72, s72, 1024
    s_mov_b32 m0, s73
    s_add_u32 s73, s73, 1024
    buffer_load_dwordx4 v8, s[24:27], s72 offen nt lds
    s_add_u32 s72, s72, 1024
    s_mov_b32 m0, s73
    s_add_u32 s73, s73, 1024
    buffer_load_dwordx4 v8, s[24:27], s72 offen nt lds
    s_add_u32 s72, s72, 1024
    s_mov_b32 m0, s73
    s_add_u32 s73, s73, 1024
    buffer_load_dwordx4 v8, s[24:27], s72 offen nt lds
    s_add_u32 s72, s72, 1024
    s_mov_b32 m0, s73
    s_add_u32 s73, s73, 1024
    buffer_load_dwordx4 v8, s[24:27], s72 offen nt lds
    s_add_u32 s72, s72, 1024
    s_mov_b32 m0, s73
    s_add_u32 s73, s73, 1024
    buffer_load_dwordx4 v8, s[24:27], s72 offen nt lds
    s_add_u32 s72, s72, 1024
    s_mov_b32 m0, s73
    s_add_u32 s73, s73, 1024
    buffer_load_dwordx4 v8, s[24:27], s72 offen nt lds
    s_add_u32 s72, s72, 1024
    s_mov_b32 m0, s73
    s_add_u32 s73, s73, 1024
    buffer_load_dwordx4 v8, s[24:27], s72 offen nt lds
    s_add_u32 s72, s72, 1024
    s_waitcnt vmcnt(12)
    s_barrier
    v_lshrrev_b32 v2, 2, v6
    v_lshl_add_u32 v2, v7, 3, v2
    v_and_b32 v3, 3, v1
    v_lshlrev_b32 v3, 3, v3
    s_cmp_ge_u32 s64, 8
    s_cbranch_scc1 a_nowuv2
    v_lshl_add_u32 v4, v2, 8, v3
    s_lshl_b32 s73, s64, 5
    v_add_u32 v4, s73, v4
    ds_read_b64_tr_b16 v[48:49], v4 offset:0
    ds_read_b64_tr_b16 v[50:51], v4 offset:1024
    ds_read_b64_tr_b16 v[52:53], v4 offset:8192
    ds_read_b64_tr_b16 v[54:55], v4 offset:9216
    ds_read_b64_tr_b16 v[56:57], v4 offset:16384
    ds_read_b64_tr_b16 v[58:59], v4 offset:17408
    ds_read_b64_tr_b16 v[60:61], v4 offset:24576
    ds_read_b64_tr_b16 v[62:63], v4 offset:25600
    s_waitcnt lgkmcnt(0)
a_nowuv2:
    s_barrier
    s_mul_i32 s72, s65, 147456
    s_lshl_b32 s73, s64, 12
    s_add_u32 s72, s72, s73
    s_mov_b32 m0, s73
    s_add_u32 s73, s73, 1024
    buffer_load_dwordx4 v8, s[24:27], s72 offen nt lds
    s_add_u32 s72, s72, 1024
    s_mov_b32 m0, s73
    s_add_u32 s73, s73, 1024
    buffer_load_dwordx4 v8, s[24:27], s72 offen nt lds
    s_add_u32 s72, s72, 1024
    s_mov_b32 m0, s73
    s_add_u32 s73, s73, 1024
    buffer_load_dwordx4 v8, s[24:27], s72 offen nt lds
    s_add_u32 s72, s72, 1024
    s_mov_b32 m0, s73
    s_add_u32 s73, s73, 1024
    buffer_load_dwordx4 v8, s[24:27], s72 offen nt lds
    s_add_u32 s72, s72, 1024
    v_mul_u32_u24 v4, 1152, v2
    v_add_u32 v4, v4, v3
    s_lshl_b32 s73, s64, 7
    v_add_u32 v4, s73, v4
    v_add_u32 v9, 73728, v4
    s_waitcnt vmcnt(0)
    s_barrier
    ds_read_b64_tr_b16 v[64:65], v4 offset:0
    ds_read_b64_tr_b16 v[66:67], v4 offset:4608
    ds_read_b64_tr_b16 v[68:69], v4 offset:36864
    ds_read_b64_tr_b16 v[70:71], v4 offset:41472
    ds_read_b64_tr_b16 v[72:73], v9 offset:0
    ds_read_b64_tr_b16 v[74:75], v9 offset:4608
    ds_read_b64_tr_b16 v[76:77], v9 offset:36864
    ds_read_b64_tr_b16 v[78:79], v9 offset:41472
    s_waitcnt lgkmcnt(0)
    ds_read_b64_tr_b16 v[80:81], v4 offset:32
    ds_read_b64_tr_b16 v[82:83], v4 offset:4640
    ds_read_b64_tr_b16 v[84:85], v4 offset:36896
    ds_read_b64_tr_b16 v[86:87], v4 offset:41504
    ds_read_b64_tr_b16 v[88:89], v9 offset:32
    ds_read_b64_tr_b16 v[90:91], v9 offset:4640
    ds_read_b64_tr_b16 v[92:93], v9 offset:36896
    ds_read_b64_tr_b16 v[94:95], v9 offset:41504
    s_waitcnt lgkmcnt(0)
    ds_read_b64_tr_b16 v[96:97], v4 offset:64
    ds_read_b64_tr_b16 v[98:99], v4 offset:4672
    ds_read_b64_tr_b16 v[100:101], v4 offset:36928
    ds_read_b64_tr_b16 v[102:103], v4 offset:41536
    ds_read_b64_tr_b16 v[104:105], v9 offset:64
    ds_read_b64_tr_b16 v[106:107], v9 offset:4672
    ds_read_b64_tr_b16 v[108:109], v9 offset:36928
    ds_read_b64_tr_b16 v[110:111], v9 offset:41536
    s_waitcnt lgkmcnt(0)
    ds_read_b64_tr_b16 v[112:113], v4 offset:96
    ds_read_b64_tr_b16 v[114:115], v4 offset:4704
    ds_read_b64_tr_b16 v[116:117], v4 offset:36960
    ds_read_b64_tr_b16 v[118:119], v4 offset:41568
    ds_read_b64_tr_b16 v[120:121], v9 offset:96
    ds_read_b64_tr_b16 v[122:123], v9 offset:4704
    ds_read_b64_tr_b16 v[124:125], v9 offset:36960
    ds_read_b64_tr_b16 v[126:127], v9 offset:41568
    s_waitcnt lgkmcnt(0)
    s_barrier
    s_cmp_lg_u32 s64, 8
    s_cbranch_scc1 poll_3_done
    v_and_b32 v2, 31, v1
    v_lshlrev_b32 v2, 4, v2
    s_and_b32 s72, s2, 7
    s_lshl_b32 s72, s72, 10
    s_add_u32 s72, s72, 991232
    s_mov_b32 s77, 0
poll_3_loop:
    buffer_load_dwordx4 v[12:15], v2, s[56:59], s72 offen sc1
    s_add_u32 s77, s77, 1
    s_waitcnt vmcnt(0)
    v_xor_b32 v12, s71, v12
    v_xor_b32 v13, s71, v13
    v_xor_b32 v14, s71, v14
    v_xor_b32 v15, s71, v15
    v_or3_b32 v12, v12, v13, v14
    v_or_b32 v12, v12, v15
    v_cmp_ne_u32 vcc, 0, v12
    s_cmp_ge_u32 s77, 200000
    s_cbranch_scc1 poll_3_done
    s_cbranch_vccnz poll_3_loop
poll_3_done:
    s_barrier
    s_cmp_ge_u32 s64, 8
    s_cbranch_scc1 p3_s1skip
    v_lshlrev_b32 v4, 17, v5
    v_and_b32 v12, 15, v5
    v_lshl_add_u32 v4, v6, 4, v4
    s_lshl_b32 s72, s65, 10
    s_lshl_b32 s73, s66, 8
    s_add_u32 s72, s72, s73
    s_add_u32 s72, s72, 16777216
    v_lshlrev_b32 v3, 3, v1
    s_lshr_b32 s73, s64, 2
    s_lshl_b32 s73, s73, 5
    s_add_u32 s73, s73, s65
    s_lshl_b32 s73, s73, 9
    s_add_u32 s73, s73, 524288
    buffer_load_dwordx2 v[32:33], v3, s[56:59], s73 offen sc1
    buffer_load_dwordx4 v[16:19], v4, s[56:59], s72 offen sc1
    s_add_u32 s72, s72, 32768
    buffer_load_dwordx4 v[20:23], v4, s[56:59], s72 offen sc1
    s_add_u32 s72, s72, 32768
    buffer_load_dwordx4 v[24:27], v4, s[56:59], s72 offen sc1
    s_add_u32 s72, s72, 32768
    buffer_load_dwordx4 v[28:31], v4, s[56:59], s72 offen sc1
    s_add_u32 s72, s72, 32768
    v_lshlrev_b32 v12, 4, v12
    s_waitcnt vmcnt(4)
    v_mov_b32 v36, v32
    s_nop 1
    v_max_f32_dpp v36, v36, v36 quad_perm:[1,0,3,2] row_mask:0xf bank_mask:0xf
    s_nop 1
    v_max_f32_dpp v36, v36, v36 quad_perm:[2,3,0,1] row_mask:0xf bank_mask:0xf
    s_nop 1
    v_max_f32_dpp v36, v36, v36 row_half_mirror row_mask:0xf bank_mask:0xf
    s_nop 1
    v_max_f32_dpp v36, v36, v36 row_mirror row_mask:0xf bank_mask:0xf
    v_mov_b32 v37, v36
    s_nop 1
    v_permlane16_swap_b32 v36, v37
    s_nop 1
    v_max_f32 v36, v36, v37
    v_mov_b32 v37, v36
    s_nop 1
    v_permlane32_swap_b32 v36, v37
    s_nop 1
    v_max_f32 v36, v36, v37
    v_sub_f32 v32, v32, v36
    v_exp_f32 v32, v32
    s_nop 0
    v_mul_f32 v36, v32, v33
    s_nop 1
    v_add_f32_dpp v36, v36, v36 quad_perm:[1,0,3,2] row_mask:0xf bank_mask:0xf
    s_nop 1
    v_add_f32_dpp v36, v36, v36 quad_perm:[2,3,0,1] row_mask:0xf bank_mask:0xf
    s_nop 1
    v_add_f32_dpp v36, v36, v36 row_half_mirror row_mask:0xf bank_mask:0xf
    s_nop 1
    v_add_f32_dpp v36, v36, v36 row_mirror row_mask:0xf bank_mask:0xf
    v_mov_b32 v37, v36
    s_nop 1
    v_permlane16_swap_b32 v36, v37
    s_nop 1
    v_add_f32 v36, v36, v37
    v_mov_b32 v37, v36
    s_nop 1
    v_permlane32_swap_b32 v36, v37
    s_nop 1
    v_add_f32 v36, v36, v37
    v_rcp_f32 v36, v36
    s_nop 0
    v_mul_f32 v36, v32, v36
    ds_bpermute_b32 v32, v12, v36
    ds_bpermute_b32 v33, v12, v36 offset:4
    ds_bpermute_b32 v34, v12, v36 offset:8
    ds_bpermute_b32 v35, v12, v36 offset:12
    s_waitcnt vmcnt(0) lgkmcnt(0)
    v_lshlrev_b32 v36, 16, v16
    v_and_b32 v37, 0xffff0000, v16
    v_mul_f32 v40, v32, v36
    v_mul_f32 v41, v32, v37
    v_lshlrev_b32 v36, 16, v17
    v_and_b32 v37, 0xffff0000, v17
    v_mul_f32 v42, v32, v36
    v_mul_f32 v43, v32, v37
    v_lshlrev_b32 v36, 16, v18
    v_and_b32 v37, 0xffff0000, v18
    v_mul_f32 v44, v32, v36
    v_mul_f32 v45, v32, v37
    v_lshlrev_b32 v36, 16, v19
    v_and_b32 v37, 0xffff0000, v19
    v_mul_f32 v46, v32, v36
    v_mul_f32 v47, v32, v37
    v_lshlrev_b32 v36, 16, v20
    v_and_b32 v37, 0xffff0000, v20
    v_fmac_f32 v40, v33, v36
    v_fmac_f32 v41, v33, v37
    v_lshlrev_b32 v36, 16, v21
    v_and_b32 v37, 0xffff0000, v21
    v_fmac_f32 v42, v33, v36
    v_fmac_f32 v43, v33, v37
    v_lshlrev_b32 v36, 16, v22
    v_and_b32 v37, 0xffff0000, v22
    v_fmac_f32 v44, v33, v36
    v_fmac_f32 v45, v33, v37
    v_lshlrev_b32 v36, 16, v23
    v_and_b32 v37, 0xffff0000, v23
    v_fmac_f32 v46, v33, v36
    v_fmac_f32 v47, v33, v37
    v_lshlrev_b32 v36, 16, v24
    v_and_b32 v37, 0xffff0000, v24
    v_fmac_f32 v40, v34, v36
    v_fmac_f32 v41, v34, v37
    v_lshlrev_b32 v36, 16, v25
    v_and_b32 v37, 0xffff0000, v25
    v_fmac_f32 v42, v34, v36
    v_fmac_f32 v43, v34, v37
    v_lshlrev_b32 v36, 16, v26
    v_and_b32 v37, 0xffff0000, v26
    v_fmac_f32 v44, v34, v36
    v_fmac_f32 v45, v34, v37
    v_lshlrev_b32 v36, 16, v27
    v_and_b32 v37, 0xffff0000, v27
    v_fmac_f32 v46, v34, v36
    v_fmac_f32 v47, v34, v37
    v_lshlrev_b32 v36, 16, v28
    v_and_b32 v37, 0xffff0000, v28
    v_fmac_f32 v40, v35, v36
    v_fmac_f32 v41, v35, v37
    v_lshlrev_b32 v36, 16, v29
    v_and_b32 v37, 0xffff0000, v29
    v_fmac_f32 v42, v35, v36
    v_fmac_f32 v43, v35, v37
    v_lshlrev_b32 v36, 16, v30
    v_and_b32 v37, 0xffff0000, v30
    v_fmac_f32 v44, v35, v36
    v_fmac_f32 v45, v35, v37
    v_lshlrev_b32 v36, 16, v31
    v_and_b32 v37, 0xffff0000, v31
    v_fmac_f32 v46, v35, v36
    v_fmac_f32 v47, v35, v37
    v_lshlrev_b32 v4, 9, v5
    v_lshl_add_u32 v4, v6, 5, v4
    ds_write_b128 v4, v[40:43] offset:2048
    ds_write_b128 v4, v[44:47] offset:2064
    s_waitcnt lgkmcnt(0)
p3_s1skip:
    s_barrier
    s_cmp_ge_u32 s64, 4
    s_cbranch_scc1 p3_r1skip
    v_and_b32 v4, 127, v0
    v_lshlrev_b32 v4, 2, v4
    v_lshrrev_b32 v12, 7, v0
    v_lshl_add_u32 v4, v12, 13, v4
    ds_read_b32 v16, v4 offset:2048
    ds_read_b32 v17, v4 offset:2560
    ds_read_b32 v18, v4 offset:3072
    ds_read_b32 v19, v4 offset:3584
    ds_read_b32 v20, v4 offset:4096
    ds_read_b32 v21, v4 offset:4608
    ds_read_b32 v22, v4 offset:5120
    ds_read_b32 v23, v4 offset:5632
    ds_read_b32 v24, v4 offset:6144
    ds_read_b32 v25, v4 offset:6656
    ds_read_b32 v26, v4 offset:7168
    ds_read_b32 v27, v4 offset:7680
    ds_read_b32 v28, v4 offset:8192
    ds_read_b32 v29, v4 offset:8704
    ds_read_b32 v30, v4 offset:9216
    ds_read_b32 v31, v4 offset:9728
    s_waitcnt lgkmcnt(0)
    v_add_f32 v16, v16, v17
    v_add_f32 v18, v18, v19
    v_add_f32 v20, v20, v21
    v_add_f32 v22, v22, v23
    v_add_f32 v24, v24, v25
    v_add_f32 v26, v26, v27
    v_add_f32 v28, v28, v29
    v_add_f32 v30, v30, v31
    v_add_f32 v16, v16, v18
    v_add_f32 v20, v20, v22
    v_add_f32 v24, v24, v26
    v_add_f32 v28, v28, v30
    v_add_f32 v16, v16, v20
    v_add_f32 v24, v24, v28
    v_add_f32 v16, v16, v24
    v_cvt_pk_bf16_f32 v16, v16, v16
    v_lshlrev_b32 v4, 1, v0
    ds_write_b16 v4, v16 offset:0
    s_waitcnt lgkmcnt(0)
p3_r1skip:
    v_lshlrev_b32 v8, 8, v6
    v_lshl_add_u32 v8, v7, 4, v8
    v_mov_b32 v16, 0
    v_mov_b32 v17, 0
    v_mov_b32 v18, 0
    v_mov_b32 v19, 0
    v_mov_b32 v20, 0
    v_mov_b32 v21, 0
    v_mov_b32 v22, 0
    v_mov_b32 v23, 0
    v_mov_b32 v24, 0
    v_mov_b32 v25, 0
    v_mov_b32 v26, 0
    v_mov_b32 v27, 0
    v_mov_b32 v28, 0
    v_mov_b32 v29, 0
    v_mov_b32 v30, 0
    v_mov_b32 v31, 0
    v_mov_b32 v32, 0
    v_mov_b32 v33, 0
    v_mov_b32 v34, 0
    v_mov_b32 v35, 0
    s_barrier
    s_cmp_ge_u32 s64, 8
    s_cbranch_scc1 p3_s2skip
    v_cmp_gt_u32 vcc, 2, v6
    s_and_saveexec_b64 s[78:79], vcc
    ds_read_b128 v[16:19], v8 offset:0
    ds_read_b128 v[20:23], v8 offset:64
    ds_read_b128 v[24:27], v8 offset:128
    ds_read_b128 v[28:31], v8 offset:192
    s_mov_b64 exec, s[78:79]
    s_waitcnt lgkmcnt(0)
    s_nop 4
    v_mfma_f32_16x16x32_bf16 v[32:35], v[16:19], v[48:51], v[32:35]
    v_mfma_f32_16x16x32_bf16 v[32:35], v[20:23], v[52:55], v[32:35]
    v_mfma_f32_16x16x32_bf16 v[32:35], v[24:27], v[56:59], v[32:35]
    v_mfma_f32_16x16x32_bf16 v[32:35], v[28:31], v[60:63], v[32:35]
    s_lshl_b32 s73, s64, 5
    v_lshlrev_b32 v4, 1, v1
    v_add_u32 v4, s73, v4
    s_nop 6
    v_cvt_pk_bf16_f32 v36, v32, v33
    v_cmp_gt_u32 vcc, 16, v1
    s_and_saveexec_b64 s[78:79], vcc
    ds_write_b16 v4, v36 offset:512
    ds_write_b16_d16_hi v4, v36 offset:768
    s_mov_b64 exec, s[78:79]
    s_waitcnt lgkmcnt(0)
p3_s2skip:
    v_mov_b32 v16, 0
    v_mov_b32 v17, 0
    v_mov_b32 v18, 0
    v_mov_b32 v19, 0
    v_mov_b32 v20, 0
    v_mov_b32 v21, 0
    v_mov_b32 v22, 0
    v_mov_b32 v23, 0
    v_mov_b32 v24, 0
    v_mov_b32 v25, 0
    v_mov_b32 v26, 0
    v_mov_b32 v27, 0
    v_mov_b32 v28, 0
    v_mov_b32 v29, 0
    v_mov_b32 v30, 0
    v_mov_b32 v31, 0
    v_mov_b32 v32, 0
    v_mov_b32 v33, 0
    v_mov_b32 v34, 0
    v_mov_b32 v35, 0
    v_mov_b32 v36, 0
    v_mov_b32 v37, 0
    v_mov_b32 v38, 0
    v_mov_b32 v39, 0
    v_mov_b32 v40, 0
    v_mov_b32 v41, 0
    v_mov_b32 v42, 0
    v_mov_b32 v43, 0
    v_mov_b32 v44, 0
    v_mov_b32 v45, 0
    v_mov_b32 v46, 0
    v_mov_b32 v47, 0
    s_barrier
    v_cmp_gt_u32 vcc, 2, v6
    s_and_saveexec_b64 s[78:79], vcc
    ds_read_b128 v[16:19], v8 offset:512
    ds_read_b128 v[20:23], v8 offset:576
    ds_read_b128 v[24:27], v8 offset:640
    ds_read_b128 v[28:31], v8 offset:704
    s_mov_b64 exec, s[78:79]
    s_waitcnt lgkmcnt(0)
    s_nop 4
    v_mfma_f32_16x16x32_bf16 v[32:35], v[64:67], v[16:19], v[32:35]
    v_mfma_f32_16x16x32_bf16 v[36:39], v[80:83], v[16:19], v[36:39]
    v_mfma_f32_16x16x32_bf16 v[40:43], v[96:99], v[16:19], v[40:43]
    v_mfma_f32_16x16x32_bf16 v[44:47], v[112:115], v[16:19], v[44:47]
    v_mfma_f32_16x16x32_bf16 v[32:35], v[68:71], v[20:23], v[32:35]
    v_mfma_f32_16x16x32_bf16 v[36:39], v[84:87], v[20:23], v[36:39]
    v_mfma_f32_16x16x32_bf16 v[40:43], v[100:103], v[20:23], v[40:43]
    v_mfma_f32_16x16x32_bf16 v[44:47], v[116:119], v[20:23], v[44:47]
    v_mfma_f32_16x16x32_bf16 v[32:35], v[72:75], v[24:27], v[32:35]
    v_mfma_f32_16x16x32_bf16 v[36:39], v[88:91], v[24:27], v[36:39]
    v_mfma_f32_16x16x32_bf16 v[40:43], v[104:107], v[24:27], v[40:43]
    v_mfma_f32_16x16x32_bf16 v[44:47], v[120:123], v[24:27], v[44:47]
    v_mfma_f32_16x16x32_bf16 v[32:35], v[76:79], v[28:31], v[32:35]
    v_mfma_f32_16x16x32_bf16 v[36:39], v[92:95], v[28:31], v[36:39]
    v_mfma_f32_16x16x32_bf16 v[40:43], v[108:111], v[28:31], v[40:43]
    v_mfma_f32_16x16x32_bf16 v[44:47], v[124:127], v[28:31], v[44:47]
    v_mul_u32_u24 v4, 2304, v6
    v_lshl_add_u32 v4, v7, 4, v4
    s_lshl_b32 s73, s64, 8
    v_add_u32 v4, s73, v4
    s_mul_i32 s72, s2, 9216
    s_add_u32 s72, s72, 2097152
    v_cmp_gt_u32 vcc, 2, v6
    v_lshlrev_b32 v3, 3, v0
    v_lshlrev_b32 v2, 4, v0
    v_mov_b32 v17, s71
    v_mov_b32 v19, s71
    s_and_saveexec_b64 s[78:79], vcc
    ds_write_b128 v4, v[32:35] offset:2048
    ds_write_b128 v4, v[36:39] offset:2112
    ds_write_b128 v4, v[40:43] offset:2176
    ds_write_b128 v4, v[44:47] offset:2240
    s_mov_b64 exec, s[78:79]
    s_waitcnt lgkmcnt(0)
    s_barrier
    ds_read_b64 v[20:21], v3 offset:2048
    s_waitcnt lgkmcnt(0)
    v_mov_b32 v16, v20
    v_mov_b32 v18, v21
    buffer_store_dwordx4 v[16:19], v2, s[56:59], s72 offen sc1
    s_endpgm
role_b:
    s_sub_u32 s75, s2, 128
    s_lshr_b32 s67, s75, 6
    s_and_b32 s68, s75, 63
    s_mov_b32 s3, s75
    v_lshlrev_b32 v8, 4, v1
    v_mov_b32 v12, -1
    v_mov_b32 v13, -1
    v_mov_b32 v14, -1
    v_mov_b32 v15, -1
    s_cmp_lg_u32 s64, 8
    s_cbranch_scc1 b_dma
    v_lshlrev_b32 v28, 9, v1
    v_and_b32 v28, 0x3fff, v28
    s_lshl_b32 s72, s67, 14
    s_lshl_b32 s73, s68, 3
    s_add_u32 s72, s72, s73
    s_add_u32 s72, s72, 524288
    v_mov_b32 v14, 0
    s_mov_b32 s77, 0
    v_mov_b32 v14, 0
nw_4_loop:
    buffer_load_dword v13, v14, s[52:55], 0 offen sc1
nw_4_chk:
    s_add_u32 s77, s77, 1
    s_waitcnt vmcnt(0)
    v_readfirstlane_b32 s71, v13
    s_cmp_ge_u32 s77, 200000
    s_cbranch_scc1 nw_4_done
    s_cmp_eq_u32 s71, 0
    s_cbranch_scc1 nw_4_loop
nw_4_done:
b_dma:
    s_barrier
    s_cmp_ge_u32 s64, 8
    s_cbranch_scc1 b_nodma
    s_lshl_b32 s72, s67, 5
    s_lshl_b32 s73, s64, 2
    s_add_u32 s72, s72, s73
    s_lshl_b32 s72, s72, 6
    s_add_u32 s72, s72, s68
    s_lshl_b32 s72, s72, 10
    s_add_u32 s72, s72, 16777216
    s_lshl_b32 s72, s75, 17
    s_lshl_b32 s73, s64, 14
    s_add_u32 s72, s72, s73
    v_xor_b32 v16, 0, v8
    v_xor_b32 v17, 16, v8
    v_xor_b32 v18, 32, v8
    v_xor_b32 v19, 48, v8
    v_xor_b32 v20, 64, v8
    v_xor_b32 v21, 80, v8
    v_xor_b32 v22, 96, v8
    v_xor_b32 v23, 112, v8
    v_xor_b32 v24, 128, v8
    v_xor_b32 v25, 144, v8
    v_xor_b32 v26, 160, v8
    v_xor_b32 v27, 176, v8
    v_xor_b32 v28, 192, v8
    v_xor_b32 v29, 208, v8
    v_xor_b32 v30, 224, v8
    v_xor_b32 v31, 240, v8
    s_mov_b32 m0, s73
    s_add_u32 s73, s73, 1024
    buffer_load_dwordx4 v16, s[8:11], s72 offen nt lds
    s_add_u32 s72, s72, 1024
    s_mov_b32 m0, s73
    s_add_u32 s73, s73, 1024
    buffer_load_dwordx4 v17, s[8:11], s72 offen nt lds
    s_add_u32 s72, s72, 1024
    s_mov_b32 m0, s73
    s_add_u32 s73, s73, 1024
    buffer_load_dwordx4 v18, s[8:11], s72 offen nt lds
    s_add_u32 s72, s72, 1024
    s_mov_b32 m0, s73
    s_add_u32 s73, s73, 1024
    buffer_load_dwordx4 v19, s[8:11], s72 offen nt lds
    s_add_u32 s72, s72, 1024
    s_mov_b32 m0, s73
    s_add_u32 s73, s73, 1024
    buffer_load_dwordx4 v20, s[8:11], s72 offen nt lds
    s_add_u32 s72, s72, 1024
    s_mov_b32 m0, s73
    s_add_u32 s73, s73, 1024
    buffer_load_dwordx4 v21, s[8:11], s72 offen nt lds
    s_add_u32 s72, s72, 1024
    s_mov_b32 m0, s73
    s_add_u32 s73, s73, 1024
    buffer_load_dwordx4 v22, s[8:11], s72 offen nt lds
    s_add_u32 s72, s72, 1024
    s_mov_b32 m0, s73
    s_add_u32 s73, s73, 1024
    buffer_load_dwordx4 v23, s[8:11], s72 offen nt lds
    s_add_u32 s72, s72, 1024
    s_mov_b32 m0, s73
    s_add_u32 s73, s73, 1024
    buffer_load_dwordx4 v24, s[8:11], s72 offen nt lds
    s_add_u32 s72, s72, 1024
    s_mov_b32 m0, s73
    s_add_u32 s73, s73, 1024
    buffer_load_dwordx4 v25, s[8:11], s72 offen nt lds
    s_add_u32 s72, s72, 1024
    s_mov_b32 m0, s73
    s_add_u32 s73, s73, 1024
    buffer_load_dwordx4 v26, s[8:11], s72 offen nt lds
    s_add_u32 s72, s72, 1024
    s_mov_b32 m0, s73
    s_add_u32 s73, s73, 1024
    buffer_load_dwordx4 v27, s[8:11], s72 offen nt lds
    s_add_u32 s72, s72, 1024
    s_mov_b32 m0, s73
    s_add_u32 s73, s73, 1024
    buffer_load_dwordx4 v28, s[8:11], s72 offen nt lds
    s_add_u32 s72, s72, 1024
    s_mov_b32 m0, s73
    s_add_u32 s73, s73, 1024
    buffer_load_dwordx4 v29, s[8:11], s72 offen nt lds
    s_add_u32 s72, s72, 1024
    s_mov_b32 m0, s73
    s_add_u32 s73, s73, 1024
    buffer_load_dwordx4 v30, s[8:11], s72 offen nt lds
    s_add_u32 s72, s72, 1024
    s_mov_b32 m0, s73
    s_add_u32 s73, s73, 1024
    buffer_load_dwordx4 v31, s[8:11], s72 offen nt lds
    s_add_u32 s72, s72, 1024
    v_and_b32 v2, 15, v1
    v_lshrrev_b32 v7, 4, v1
    s_lshl_b32 s73, s64, 4
    v_add_u32 v3, s73, v2
    v_lshlrev_b32 v3, 10, v3
    v_add_u32 v12, 0, v7
    v_xor_b32 v12, v12, v2
    v_lshl_add_u32 v12, v12, 4, v3
    v_add_u32 v13, 4, v7
    v_xor_b32 v13, v13, v2
    v_lshl_add_u32 v13, v13, 4, v3
    v_add_u32 v14, 8, v7
    v_xor_b32 v14, v14, v2
    v_lshl_add_u32 v14, v14, 4, v3
    v_add_u32 v15, 12, v7
    v_xor_b32 v15, v15, v2
    v_lshl_add_u32 v15, v15, 4, v3
    s_waitcnt vmcnt(0)
    ds_read_b128 v[16:19], v12 offset:0
    ds_read_b128 v[20:23], v13 offset:0
    ds_read_b128 v[24:27], v14 offset:0
    ds_read_b128 v[28:31], v15 offset:0
    ds_read_b128 v[32:35], v12 offset:256
    ds_read_b128 v[36:39], v13 offset:256
    ds_read_b128 v[40:43], v14 offset:256
    ds_read_b128 v[44:47], v15 offset:256
    ds_read_b128 v[48:51], v12 offset:512
    ds_read_b128 v[52:55], v13 offset:512
    ds_read_b128 v[56:59], v14 offset:512
    ds_read_b128 v[60:63], v15 offset:512
    ds_read_b128 v[64:67], v12 offset:768
    ds_read_b128 v[68:71], v13 offset:768
    ds_read_b128 v[72:75], v14 offset:768
    ds_read_b128 v[76:79], v15 offset:768
    s_waitcnt lgkmcnt(0)
b_nodma:
    s_cmp_lg_u32 s64, 8
    s_cbranch_scc1 poll_5_done
    v_and_b32 v2, 31, v1
    v_lshlrev_b32 v2, 4, v2
    s_and_b32 s72, s2, 7
    s_lshl_b32 s72, s72, 10
    s_add_u32 s72, s72, 983040
    s_mov_b32 s77, 0
poll_5_loop:
    buffer_load_dwordx4 v[12:15], v2, s[56:59], s72 offen sc1
    s_add_u32 s77, s77, 1
    s_waitcnt vmcnt(0)
    v_xor_b32 v12, s71, v12
    v_xor_b32 v13, s71, v13
    v_xor_b32 v14, s71, v14
    v_xor_b32 v15, s71, v15
    v_or3_b32 v12, v12, v13, v14
    v_or_b32 v12, v12, v15
    v_cmp_ne_u32 vcc, 0, v12
    s_cmp_ge_u32 s77, 200000
    s_cbranch_scc1 poll_5_done
    s_cbranch_vccnz poll_5_loop
poll_5_done:
    s_barrier
    v_lshlrev_b32 v4, 4, v0
    s_lshl_b32 s72, s67, 15
    s_cmp_ge_u32 s64, 8
    s_cbranch_scc1 b_noqa
    s_mov_b32 s73, s72
    buffer_load_dwordx4 v[80:83], v4, s[56:59], s73 offen sc1
    s_add_u32 s73, s73, 8192
    buffer_load_dwordx4 v[84:87], v4, s[56:59], s73 offen sc1
    s_add_u32 s73, s73, 8192
    buffer_load_dwordx4 v[88:91], v4, s[56:59], s73 offen sc1
    s_add_u32 s73, s73, 8192
    buffer_load_dwordx4 v[92:95], v4, s[56:59], s73 offen sc1
    s_add_u32 s73, s73, 8192
    v_lshrrev_b32 v4, 2, v1
    v_lshlrev_b32 v4, 11, v4
    v_and_b32 v5, 3, v1
    v_lshl_add_u32 v4, v5, 8, v4
    v_add_u32 v4, 131072, v4
    v_xor_b32 v5, s64, v2
    v_xor_b32 v6, 8, v5
    v_lshl_add_u32 v5, v5, 4, v4
    v_lshl_add_u32 v6, v6, 4, v4
    s_waitcnt vmcnt(0)
    ds_write_b128 v5, v[80:83]
    ds_write_b128 v6, v[84:87]
    ds_write_b128 v5, v[88:91] offset:1024
    ds_write_b128 v6, v[92:95] offset:1024
    s_waitcnt lgkmcnt(0)
b_noqa:
    s_barrier
    s_sub_u32 s76, s75, 36
    v_mul_u32_u24 v10, 911, v0
    v_lshrrev_b32 v10, 16, v10
    v_mul_u32_u24 v11, 72, v10
    v_sub_u32 v11, v0, v11
    s_cmp_ge_u32 s76, 72
    s_cbranch_scc1 ffnp_6
    v_lshrrev_b32 v5, 3, v0
    v_and_b32 v6, 7, v0
    v_mov_b32 v4, 73728
    v_mul_lo_u32 v4, v5, v4
    v_lshl_add_u32 v4, v6, 4, v4
    s_lshl_b32 s74, s76, 7
    s_add_u32 s74, s74, 0
    buffer_load_dwordx4 v[104:107], v4, s[28:31], s74 offen nt
    s_add_u32 s74, s74, 9216
    buffer_load_dwordx4 v[108:111], v4, s[28:31], s74 offen nt
    s_add_u32 s74, s74, 9216
    buffer_load_dwordx4 v[112:115], v4, s[28:31], s74 offen nt
    s_add_u32 s74, s74, 9216
    buffer_load_dwordx4 v[116:119], v4, s[28:31], s74 offen nt
ffnp_6:
    s_cmp_ge_u32 s64, 8
    s_cbranch_scc1 b_qk_skip
    v_lshlrev_b32 v9, 8, v7
    v_add_u32 v9, 131072, v9
    v_add_u32 v12, 0, v7
    v_xor_b32 v12, v12, v2
    v_lshl_add_u32 v12, v12, 4, v9
    v_add_u32 v13, 4, v7
    v_xor_b32 v13, v13, v2
    v_lshl_add_u32 v13, v13, 4, v9
    v_add_u32 v14, 8, v7
    v_xor_b32 v14, v14, v2
    v_lshl_add_u32 v14, v14, 4, v9
    v_add_u32 v15, 12, v7
    v_xor_b32 v15, v15, v2
    v_lshl_add_u32 v15, v15, 4, v9
    v_mov_b32 v96, 0
    v_mov_b32 v97, 0
    v_mov_b32 v98, 0
    v_mov_b32 v99, 0
    v_mov_b32 v100, 0
    v_mov_b32 v101, 0
    v_mov_b32 v102, 0
    v_mov_b32 v103, 0
    ds_read_b128 v[80:83], v12 offset:0
    ds_read_b128 v[84:87], v12 offset:1024
    ds_read_b128 v[88:91], v13 offset:2048
    ds_read_b128 v[92:95], v13 offset:3072
    s_waitcnt lgkmcnt(2)
    v_mfma_f32_16x16x32_bf16 v[96:99], v[16:19], v[80:83], v[96:99]
    v_mfma_f32_16x16x32_bf16 v[100:103], v[16:19], v[84:87], v[100:103]
    s_nop 1
    ds_read_b128 v[80:83], v14 offset:4096
    ds_read_b128 v[84:87], v14 offset:5120
    s_waitcnt lgkmcnt(2)
    v_mfma_f32_16x16x32_bf16 v[96:99], v[20:23], v[88:91], v[96:99]
    v_mfma_f32_16x16x32_bf16 v[100:103], v[20:23], v[92:95], v[100:103]
    s_nop 1
    ds_read_b128 v[88:91], v15 offset:6144
    ds_read_b128 v[92:95], v15 offset:7168
    s_waitcnt lgkmcnt(2)
    v_mfma_f32_16x16x32_bf16 v[96:99], v[24:27], v[80:83], v[96:99]
    v_mfma_f32_16x16x32_bf16 v[100:103], v[24:27], v[84:87], v[100:103]
    s_nop 1
    ds_read_b128 v[80:83], v12 offset:8192
    ds_read_b128 v[84:87], v12 offset:9216
    s_waitcnt lgkmcnt(2)
    v_mfma_f32_16x16x32_bf16 v[96:99], v[28:31], v[88:91], v[96:99]
    v_mfma_f32_16x16x32_bf16 v[100:103], v[28:31], v[92:95], v[100:103]
    s_nop 1
    ds_read_b128 v[88:91], v13 offset:10240
    ds_read_b128 v[92:95], v13 offset:11264
    s_waitcnt lgkmcnt(2)
    v_mfma_f32_16x16x32_bf16 v[96:99], v[32:35], v[80:83], v[96:99]
    v_mfma_f32_16x16x32_bf16 v[100:103], v[32:35], v[84:87], v[100:103]
    s_nop 1
    ds_read_b128 v[80:83], v14 offset:12288
    ds_read_b128 v[84:87], v14 offset:13312
    s_waitcnt lgkmcnt(2)
    v_mfma_f32_16x16x32_bf16 v[96:99], v[36:39], v[88:91], v[96:99]
    v_mfma_f32_16x16x32_bf16 v[100:103], v[36:39], v[92:95], v[100:103]
    s_nop 1
    ds_read_b128 v[88:91], v15 offset:14336
    ds_read_b128 v[92:95], v15 offset:15360
    s_waitcnt lgkmcnt(2)
    v_mfma_f32_16x16x32_bf16 v[96:99], v[40:43], v[80:83], v[96:99]
    v_mfma_f32_16x16x32_bf16 v[100:103], v[40:43], v[84:87], v[100:103]
    s_nop 1
    ds_read_b128 v[80:83], v12 offset:16384
    ds_read_b128 v[84:87], v12 offset:17408
    s_waitcnt lgkmcnt(2)
    v_mfma_f32_16x16x32_bf16 v[96:99], v[44:47], v[88:91], v[96:99]
    v_mfma_f32_16x16x32_bf16 v[100:103], v[44:47], v[92:95], v[100:103]
    s_nop 1
    ds_read_b128 v[88:91], v13 offset:18432
    ds_read_b128 v[92:95], v13 offset:19456
    s_waitcnt lgkmcnt(2)
    v_mfma_f32_16x16x32_bf16 v[96:99], v[48:51], v[80:83], v[96:99]
    v_mfma_f32_16x16x32_bf16 v[100:103], v[48:51], v[84:87], v[100:103]
    s_nop 1
    ds_read_b128 v[80:83], v14 offset:20480
    ds_read_b128 v[84:87], v14 offset:21504
    s_waitcnt lgkmcnt(2)
    v_mfma_f32_16x16x32_bf16 v[96:99], v[52:55], v[88:91], v[96:99]
    v_mfma_f32_16x16x32_bf16 v[100:103], v[52:55], v[92:95], v[100:103]
    s_nop 1
    ds_read_b128 v[88:91], v15 offset:22528
    ds_read_b128 v[92:95], v15 offset:23552
    s_waitcnt lgkmcnt(2)
    v_mfma_f32_16x16x32_bf16 v[96:99], v[56:59], v[80:83], v[96:99]
    v_mfma_f32_16x16x32_bf16 v[100:103], v[56:59], v[84:87], v[100:103]
    s_nop 1
    ds_read_b128 v[80:83], v12 offset:24576
    ds_read_b128 v[84:87], v12 offset:25600
    s_waitcnt lgkmcnt(2)
    v_mfma_f32_16x16x32_bf16 v[96:99], v[60:63], v[88:91], v[96:99]
    v_mfma_f32_16x16x32_bf16 v[100:103], v[60:63], v[92:95], v[100:103]
    s_nop 1
    ds_read_b128 v[88:91], v13 offset:26624
    ds_read_b128 v[92:95], v13 offset:27648
    s_waitcnt lgkmcnt(2)
    v_mfma_f32_16x16x32_bf16 v[96:99], v[64:67], v[80:83], v[96:99]
    v_mfma_f32_16x16x32_bf16 v[100:103], v[64:67], v[84:87], v[100:103]
    s_nop 1
    ds_read_b128 v[80:83], v14 offset:28672
    ds_read_b128 v[84:87], v14 offset:29696
    s_waitcnt lgkmcnt(2)
    v_mfma_f32_16x16x32_bf16 v[96:99], v[68:71], v[88:91], v[96:99]
    v_mfma_f32_16x16x32_bf16 v[100:103], v[68:71], v[92:95], v[100:103]
    s_nop 1
    ds_read_b128 v[88:91], v15 offset:30720
    ds_read_b128 v[92:95], v15 offset:31744
    s_waitcnt lgkmcnt(2)
    v_mfma_f32_16x16x32_bf16 v[96:99], v[72:75], v[80:83], v[96:99]
    v_mfma_f32_16x16x32_bf16 v[100:103], v[72:75], v[84:87], v[100:103]
    s_waitcnt lgkmcnt(0)
    v_mfma_f32_16x16x32_bf16 v[96:99], v[76:79], v[88:91], v[96:99]
    v_mfma_f32_16x16x32_bf16 v[100:103], v[76:79], v[92:95], v[100:103]
    v_lshrrev_b32 v84, 2, v2
    v_lshlrev_b32 v84, 2, v84
    v_lshrrev_b32 v85, 5, v1
    v_lshl_add_u32 v84, v85, 1, v84
    v_and_b32 v85, 1, v7
    v_lshlrev_b32 v85, 1, v85
    v_bfe_u32 v86, v1, 1, 1
    v_add_u32 v85, v85, v86
    s_and_b32 s73, s64, 1
    s_lshl_b32 s73, s73, 3
    v_add_u32 v85, s73, v85
    v_and_b32 v86, 1, v1
    v_lshlrev_b32 v86, 3, v86
    s_lshr_b32 s73, s64, 1
    s_lshl_b32 s73, s73, 8
    v_add_u32 v86, s73, v86
    v_add_u32 v87, 0, v84
    v_add_u32 v88, 0, v85
    v_xor_b32 v88, v88, v87
    v_lshl_add_u32 v12, v87, 10, v86
    v_lshl_add_u32 v12, v88, 4, v12
    v_add_u32 v87, 1, v84
    v_add_u32 v88, 0, v85
    v_xor_b32 v88, v88, v87
    v_lshl_add_u32 v13, v87, 10, v86
    v_lshl_add_u32 v13, v88, 4, v13
    v_add_u32 v87, 0, v84
    v_add_u32 v88, 4, v85
    v_xor_b32 v88, v88, v87
    v_lshl_add_u32 v14, v87, 10, v86
    v_lshl_add_u32 v14, v88, 4, v14
    v_add_u32 v87, 1, v84
    v_add_u32 v88, 4, v85
    v_xor_b32 v88, v88, v87
    v_lshl_add_u32 v15, v87, 10, v86
    v_lshl_add_u32 v15, v88, 4, v15
    s_mov_b32 s73, 1040356334
    v_mul_f32 v96, s73, v96
    v_mul_f32 v97, s73, v97
    v_mul_f32 v98, s73, v98
    v_mul_f32 v99, s73, v99
    v_mul_f32 v100, s73, v100
    v_mul_f32 v101, s73, v101
    v_mul_f32 v102, s73, v102
    v_mul_f32 v103, s73, v103
    v_max3_f32 v80, v96, v97, v98
    v_max_f32 v80, v80, v99
    v_max3_f32 v81, v100, v101, v102
    v_max_f32 v81, v81, v103
    ds_read_b64_tr_b16 v[16:17], v12 offset:0
    ds_read_b64_tr_b16 v[18:19], v13 offset:0
    ds_read_b64_tr_b16 v[20:21], v14 offset:0
    ds_read_b64_tr_b16 v[22:23], v15 offset:0
    ds_read_b64_tr_b16 v[24:25], v12 offset:16384
    ds_read_b64_tr_b16 v[26:27], v13 offset:16384
    ds_read_b64_tr_b16 v[28:29], v14 offset:16384
    ds_read_b64_tr_b16 v[30:31], v15 offset:16384
    ds_read_b64_tr_b16 v[32:33], v12 offset:32768
    ds_read_b64_tr_b16 v[34:35], v13 offset:32768
    ds_read_b64_tr_b16 v[36:37], v14 offset:32768
    ds_read_b64_tr_b16 v[38:39], v15 offset:32768
    ds_read_b64_tr_b16 v[40:41], v12 offset:49152
    ds_read_b64_tr_b16 v[42:43], v13 offset:49152
    ds_read_b64_tr_b16 v[44:45], v14 offset:49152
    ds_read_b64_tr_b16 v[46:47], v15 offset:49152
    v_add_u32 v12, 0x10000, v12
    v_add_u32 v13, 0x10000, v13
    v_add_u32 v14, 0x10000, v14
    v_add_u32 v15, 0x10000, v15
    ds_read_b64_tr_b16 v[48:49], v12 offset:0
    ds_read_b64_tr_b16 v[50:51], v13 offset:0
    ds_read_b64_tr_b16 v[52:53], v14 offset:0
    ds_read_b64_tr_b16 v[54:55], v15 offset:0
    ds_read_b64_tr_b16 v[56:57], v12 offset:16384
    ds_read_b64_tr_b16 v[58:59], v13 offset:16384
    ds_read_b64_tr_b16 v[60:61], v14 offset:16384
    ds_read_b64_tr_b16 v[62:63], v15 offset:16384
    ds_read_b64_tr_b16 v[64:65], v12 offset:32768
    ds_read_b64_tr_b16 v[66:67], v13 offset:32768
    ds_read_b64_tr_b16 v[68:69], v14 offset:32768
    ds_read_b64_tr_b16 v[70:71], v15 offset:32768
    ds_read_b64_tr_b16 v[72:73], v12 offset:49152
    ds_read_b64_tr_b16 v[74:75], v13 offset:49152
    ds_read_b64_tr_b16 v[76:77], v14 offset:49152
    ds_read_b64_tr_b16 v[78:79], v15 offset:49152
    v_mov_b32 v82, v80
    s_nop 1
    v_permlane16_swap_b32 v80, v82
    s_nop 1
    v_max_f32 v80, v80, v82
    v_mov_b32 v82, v80
    s_nop 1
    v_permlane32_swap_b32 v80, v82
    s_nop 1
    v_max_f32 v80, v80, v82
    v_mov_b32 v82, v81
    s_nop 1
    v_permlane16_swap_b32 v81, v82
    s_nop 1
    v_max_f32 v81, v81, v82
    v_mov_b32 v82, v81
    s_nop 1
    v_permlane32_swap_b32 v81, v82
    s_nop 1
    v_max_f32 v81, v81, v82
b_qk_skip:
    s_cmp_ge_u32 s76, 72
    s_cbranch_scc1 ffnp_7
    v_lshrrev_b32 v5, 3, v0
    v_and_b32 v6, 7, v0
    v_mov_b32 v4, 73728
    v_mul_lo_u32 v4, v5, v4
    v_lshl_add_u32 v4, v6, 4, v4
    s_lshl_b32 s74, s76, 7
    s_add_u32 s74, s74, 36864
    buffer_load_dwordx4 v[120:123], v4, s[28:31], s74 offen nt
    s_add_u32 s74, s74, 9216
    buffer_load_dwordx4 v[124:127], v4, s[28:31], s74 offen nt
    s_add_u32 s74, s74, 9216
    buffer_load_dwordx4 v[128:131], v4, s[28:31], s74 offen nt
    s_add_u32 s74, s74, 9216
    buffer_load_dwordx4 v[132:135], v4, s[28:31], s74 offen nt
ffnp_7:
    s_barrier
    s_cmp_ge_u32 s64, 8
    s_cbranch_scc1 b_mx_skip
    v_lshlrev_b32 v12, 5, v2
    v_add_u32 v12, 131072, v12
    s_lshl_b32 s73, s64, 2
    v_add_u32 v13, s73, v12
    ds_write_b32 v13, v80 offset:8192
    ds_write_b32 v13, v81 offset:8704
    s_waitcnt lgkmcnt(0)
b_mx_skip:
    s_barrier
    s_cmp_ge_u32 s64, 8
    s_cbranch_scc1 b_sm_skip
    ds_read_b128 v[80:83], v12 offset:8192
    ds_read_b128 v[84:87], v12 offset:8208
    ds_read_b128 v[88:91], v12 offset:8704
    ds_read_b128 v[92:95], v12 offset:8720
    s_waitcnt lgkmcnt(0)
    v_max3_f32 v80, v80, v81, v82
    v_max3_f32 v80, v80, v83, v84
    v_max3_f32 v80, v80, v85, v86
    v_max_f32 v80, v80, v87
    v_max3_f32 v81, v88, v89, v90
    v_max3_f32 v81, v81, v91, v92
    v_max3_f32 v81, v81, v93, v94
    v_max_f32 v81, v81, v95
    v_sub_f32 v96, v96, v80
    v_sub_f32 v100, v100, v81
    v_sub_f32 v97, v97, v80
    v_sub_f32 v101, v101, v81
    v_sub_f32 v98, v98, v80
    v_sub_f32 v102, v102, v81
    v_sub_f32 v99, v99, v80
    v_sub_f32 v103, v103, v81
    v_exp_f32 v96, v96
    v_exp_f32 v97, v97
    v_exp_f32 v98, v98
    v_exp_f32 v99, v99
    v_exp_f32 v100, v100
    v_exp_f32 v101, v101
    v_exp_f32 v102, v102
    v_exp_f32 v103, v103
    s_nop 0
    v_add_f32 v84, v96, v97
    v_add_f32 v85, v98, v99
    v_add_f32 v84, v84, v85
    v_add_f32 v85, v100, v101
    v_add_f32 v86, v102, v103
    v_add_f32 v85, v85, v86
    v_cvt_pk_bf16_f32 v86, v96, v97
    v_cvt_pk_bf16_f32 v87, v98, v99
    v_cvt_pk_bf16_f32 v88, v100, v101
    v_cvt_pk_bf16_f32 v89, v102, v103
    s_lshl_b32 s73, s64, 10
    s_add_u32 s73, s73, 131072
    v_lshlrev_b32 v90, 4, v2
    v_lshl_add_u32 v90, v7, 1, v90
    v_add_u32 v90, s73, v90
    ds_write_b16 v90, v86
    ds_write_b16_d16_hi v90, v86 offset:8
    ds_write_b16 v90, v87 offset:512
    ds_write_b16_d16_hi v90, v87 offset:520
    ds_write_b16 v90, v88 offset:256
    ds_write_b16_d16_hi v90, v88 offset:264
    ds_write_b16 v90, v89 offset:768
    ds_write_b16_d16_hi v90, v89 offset:776
    v_mov_b32 v91, v84
    s_nop 1
    v_permlane16_swap_b32 v84, v91
    s_nop 1
    v_add_f32 v84, v84, v91
    v_mov_b32 v91, v84
    s_nop 1
    v_permlane32_swap_b32 v84, v91
    s_nop 1
    v_add_f32 v84, v84, v91
    v_mov_b32 v91, v85
    s_nop 1
    v_permlane16_swap_b32 v85, v91
    s_nop 1
    v_add_f32 v85, v85, v91
    v_mov_b32 v91, v85
    s_nop 1
    v_permlane32_swap_b32 v85, v91
    s_nop 1
    v_add_f32 v85, v85, v91
    ds_write_b32 v13, v84 offset:9216
    ds_write_b32 v13, v85 offset:9728
    v_mov_b32 v136, 0
    v_mov_b32 v137, 0
    v_mov_b32 v138, 0
    v_mov_b32 v139, 0
    v_mov_b32 v140, 0
    v_mov_b32 v141, 0
    v_mov_b32 v142, 0
    v_mov_b32 v143, 0
    v_mov_b32 v144, 0
    v_mov_b32 v145, 0
    v_mov_b32 v146, 0
    v_mov_b32 v147, 0
    v_mov_b32 v148, 0
    v_mov_b32 v149, 0
    v_mov_b32 v150, 0
    v_mov_b32 v151, 0
    v_mov_b32 v152, 0
    v_mov_b32 v153, 0
    v_mov_b32 v154, 0
    v_mov_b32 v155, 0
    v_mov_b32 v156, 0
    v_mov_b32 v157, 0
    v_mov_b32 v158, 0
    v_mov_b32 v159, 0
    v_mov_b32 v160, 0
    v_mov_b32 v161, 0
    v_mov_b32 v162, 0
    v_mov_b32 v163, 0
    v_mov_b32 v164, 0
    v_mov_b32 v165, 0
    v_mov_b32 v166, 0
    v_mov_b32 v167, 0
    v_add_u32 v9, 131072, v8
    s_waitcnt lgkmcnt(0)
b_sm_skip:
    s_barrier
    s_cmp_lt_u32 s64, 8
    s_cbranch_scc1 b_pv_go
    v_lshlrev_b32 v28, 5, v1
    v_add_u32 v28, 131072, v28
    v_cmp_gt_u32 vcc, 32, v1
    s_and_saveexec_b64 s[78:79], vcc
    ds_read_b128 v[12:15], v28 offset:8192
    ds_read_b128 v[16:19], v28 offset:8208
    ds_read_b128 v[20:23], v28 offset:9216
    ds_read_b128 v[24:27], v28 offset:9232
    s_waitcnt lgkmcnt(0)
    v_max3_f32 v12, v12, v13, v14
    v_max3_f32 v12, v12, v15, v16
    v_max3_f32 v12, v12, v17, v18
    v_max_f32 v12, v12, v19
    v_add_f32 v20, v20, v21
    v_add_f32 v22, v22, v23
    v_add_f32 v24, v24, v25
    v_add_f32 v26, v26, v27
    v_add_f32 v20, v20, v22
    v_add_f32 v24, v24, v26
    v_add_f32 v20, v20, v24
    v_mov_b32 v13, v20
    v_lshlrev_b32 v28, 9, v1
    s_lshl_b32 s72, s67, 14
    s_lshl_b32 s73, s68, 3
    s_add_u32 s72, s72, s73
    s_add_u32 s72, s72, 524288
    buffer_store_dwordx2 v[12:13], v28, s[56:59], s72 offen sc1
    s_mov_b64 exec, s[78:79]
    s_branch b_pv_skip
b_pv_go:
    ds_read_b128 v[80:83], v9 offset:0
    ds_read_b128 v[84:87], v9 offset:1024
    ds_read_b128 v[88:91], v9 offset:2048
    ds_read_b128 v[92:95], v9 offset:3072
    ds_read_b128 v[96:99], v9 offset:4096
    ds_read_b128 v[100:103], v9 offset:5120
    s_waitcnt lgkmcnt(5)
    v_mfma_f32_32x32x16_bf16 v[136:151], v[16:19], v[80:83], v[136:151]
    v_mfma_f32_32x32x16_bf16 v[152:167], v[20:23], v[80:83], v[152:167]
    s_nop 3
    ds_read_b128 v[80:83], v9 offset:6144
    s_waitcnt lgkmcnt(5)
    v_mfma_f32_32x32x16_bf16 v[136:151], v[24:27], v[84:87], v[136:151]
    v_mfma_f32_32x32x16_bf16 v[152:167], v[28:31], v[84:87], v[152:167]
    s_nop 3
    ds_read_b128 v[84:87], v9 offset:7168
    s_waitcnt lgkmcnt(5)
    v_mfma_f32_32x32x16_bf16 v[136:151], v[32:35], v[88:91], v[136:151]
    v_mfma_f32_32x32x16_bf16 v[152:167], v[36:39], v[88:91], v[152:167]
    s_waitcnt lgkmcnt(4)
    v_mfma_f32_32x32x16_bf16 v[136:151], v[40:43], v[92:95], v[136:151]
    v_mfma_f32_32x32x16_bf16 v[152:167], v[44:47], v[92:95], v[152:167]
    s_waitcnt lgkmcnt(3)
    v_mfma_f32_32x32x16_bf16 v[136:151], v[48:51], v[96:99], v[136:151]
    v_mfma_f32_32x32x16_bf16 v[152:167], v[52:55], v[96:99], v[152:167]
    s_waitcnt lgkmcnt(2)
    v_mfma_f32_32x32x16_bf16 v[136:151], v[56:59], v[100:103], v[136:151]
    v_mfma_f32_32x32x16_bf16 v[152:167], v[60:63], v[100:103], v[152:167]
    s_waitcnt lgkmcnt(1)
    v_mfma_f32_32x32x16_bf16 v[136:151], v[64:67], v[80:83], v[136:151]
    v_mfma_f32_32x32x16_bf16 v[152:167], v[68:71], v[80:83], v[152:167]
    s_waitcnt lgkmcnt(0)
    v_mfma_f32_32x32x16_bf16 v[136:151], v[72:75], v[84:87], v[136:151]
    v_mfma_f32_32x32x16_bf16 v[152:167], v[76:79], v[84:87], v[152:167]
    s_nop 7
    s_nop 7
    v_cvt_pk_bf16_f32 v16, v136, v137
    v_cvt_pk_bf16_f32 v17, v138, v139
    v_cvt_pk_bf16_f32 v18, v140, v141
    v_cvt_pk_bf16_f32 v19, v142, v143
    v_cvt_pk_bf16_f32 v20, v144, v145
    v_cvt_pk_bf16_f32 v21, v146, v147
    v_cvt_pk_bf16_f32 v22, v148, v149
    v_cvt_pk_bf16_f32 v23, v150, v151
    v_cvt_pk_bf16_f32 v24, v152, v153
    v_cvt_pk_bf16_f32 v25, v154, v155
    v_cvt_pk_bf16_f32 v26, v156, v157
    v_cvt_pk_bf16_f32 v27, v158, v159
    v_cvt_pk_bf16_f32 v28, v160, v161
    v_cvt_pk_bf16_f32 v29, v162, v163
    v_cvt_pk_bf16_f32 v30, v164, v165
    v_cvt_pk_bf16_f32 v31, v166, v167
    s_nop 1
    v_permlane32_swap_b32 v16, v18
    v_permlane32_swap_b32 v17, v19
    v_permlane32_swap_b32 v20, v22
    v_permlane32_swap_b32 v21, v23
    v_permlane32_swap_b32 v24, v26
    v_permlane32_swap_b32 v25, v27
    v_permlane32_swap_b32 v28, v30
    v_permlane32_swap_b32 v29, v31
b_pv_skip:
    s_barrier
    s_cmp_ge_u32 s64, 8
    s_cbranch_scc1 b_ow_skip
    v_and_b32 v32, 31, v1
    v_mul_u32_u24 v32, 1040, v32
    v_lshrrev_b32 v33, 5, v1
    v_lshl_add_u32 v32, v33, 4, v32
    s_lshl_b32 s73, s64, 7
    v_add_u32 v32, s73, v32
    ds_write_b128 v32, v[16:19]
    ds_write_b128 v32, v[20:23] offset:32
    ds_write_b128 v32, v[24:27] offset:64
    ds_write_b128 v32, v[28:31] offset:96
    s_waitcnt lgkmcnt(0)
b_ow_skip:
    s_barrier
    s_cmp_ge_u32 s64, 8
    s_cbranch_scc1 b_ml
    s_mul_i32 s73, s64, 4160
    v_add_u32 v29, s73, v8
    ds_read_b128 v[32:35], v29
    ds_read_b128 v[36:39], v29 offset:1040
    ds_read_b128 v[40:43], v29 offset:2080
    ds_read_b128 v[44:47], v29 offset:3120
    s_lshl_b32 s72, s75, 15
    s_lshl_b32 s73, s64, 12
    s_add_u32 s72, s72, s73
    s_add_u32 s72, s72, 16777216
    s_waitcnt lgkmcnt(3)
    buffer_store_dwordx4 v[32:35], v8, s[56:59], s72 offen offset:0 sc1
    s_waitcnt lgkmcnt(2)
    buffer_store_dwordx4 v[36:39], v8, s[56:59], s72 offen offset:1024 sc1
    s_waitcnt lgkmcnt(1)
    buffer_store_dwordx4 v[40:43], v8, s[56:59], s72 offen offset:2048 sc1
    s_waitcnt lgkmcnt(0)
    buffer_store_dwordx4 v[44:47], v8, s[56:59], s72 offen offset:3072 sc1
    s_branch b_st_done
b_ml:
b_st_done:
    s_waitcnt vmcnt(0)
    s_barrier
    s_cmp_lg_u32 s64, 8
    s_cbranch_scc1 sig_8
    s_lshl_b32 s72, s3, 2
    s_add_u32 s72, s72, 991232
    v_mov_b32 v2, s71
    v_lshlrev_b32 v3, 10, v1
    v_cmp_gt_u32 vcc, 8, v1
    s_and_saveexec_b64 s[78:79], vcc
    buffer_store_dword v2, v3, s[56:59], s72 offen sc1
    s_mov_b64 exec, s[78:79]
sig_8:
    s_barrier
    s_cmp_ge_u32 s76, 72
    s_cbranch_scc1 ffn_done
    v_lshrrev_b32 v2, 3, v0
    v_and_b32 v3, 7, v0
    v_lshlrev_b32 v4, 4, v2
    buffer_load_dwordx4 v[88:91], v4, s[4:7], 0 offen
    buffer_load_dwordx4 v[92:95], v4, s[4:7], 0 offen offset:1152
    v_lshlrev_b32 v9, 1, v1
    s_lshl_b32 s72, s76, 7
    buffer_load_ushort v12, v9, s[32:35], s72 offen
    s_barrier
    s_cmp_ge_u32 s76, 72
    s_cbranch_scc1 ffnp_9
    v_mul_u32_u24 v4, 9216, v10
    v_lshl_add_u32 v4, v11, 4, v4
    s_mul_i32 s74, s76, 73728
    s_add_u32 s74, s74, 0
    buffer_load_dwordx4 v[136:139], v4, s[36:39], s74 offen offset:0 nt
    buffer_load_dwordx4 v[140:143], v4, s[36:39], s74 offen offset:1152 nt
    buffer_load_dwordx4 v[144:147], v4, s[36:39], s74 offen offset:2304 nt
    buffer_load_dwordx4 v[148:151], v4, s[36:39], s74 offen offset:3456 nt
ffnp_9:
    s_cmp_ge_u32 s76, 72
    s_cbranch_scc1 ffnp_10
    v_mul_u32_u24 v4, 9216, v10
    v_lshl_add_u32 v4, v11, 4, v4
    s_mul_i32 s74, s76, 73728
    s_add_u32 s74, s74, 4608
    buffer_load_dwordx4 v[152:155], v4, s[36:39], s74 offen offset:0 nt
    buffer_load_dwordx4 v[156:159], v4, s[36:39], s74 offen offset:1152 nt
    buffer_load_dwordx4 v[160:163], v4, s[36:39], s74 offen offset:2304 nt
    buffer_load_dwordx4 v[164:167], v4, s[36:39], s74 offen offset:3456 nt
ffnp_10:
    v_mov_b32 v16, 0
    v_mov_b32 v17, 0
    v_mov_b32 v18, 0
    v_mov_b32 v19, 0
    v_mov_b32 v20, 0
    v_mov_b32 v21, 0
    v_mov_b32 v22, 0
    v_mov_b32 v23, 0
    v_mov_b32 v24, 0
    v_mov_b32 v25, 0
    v_mov_b32 v26, 0
    v_mov_b32 v27, 0
    v_mov_b32 v28, 0
    v_mov_b32 v29, 0
    v_mov_b32 v30, 0
    v_mov_b32 v31, 0
    s_waitcnt vmcnt(8)
    v_perm_b32 v14, v108, v104, s69
    v_perm_b32 v15, v108, v104, s70
    v_dot2c_f32_bf16 v16, v14, v88
    v_dot2c_f32_bf16 v17, v15, v88
    v_dot2c_f32_bf16 v24, v14, v92
    v_dot2c_f32_bf16 v25, v15, v92
    v_perm_b32 v14, v109, v105, s69
    v_perm_b32 v15, v109, v105, s70
    v_dot2c_f32_bf16 v18, v14, v88
    v_dot2c_f32_bf16 v19, v15, v88
    v_dot2c_f32_bf16 v26, v14, v92
    v_dot2c_f32_bf16 v27, v15, v92
    v_perm_b32 v14, v110, v106, s69
    v_perm_b32 v15, v110, v106, s70
    v_dot2c_f32_bf16 v20, v14, v88
    v_dot2c_f32_bf16 v21, v15, v88
    v_dot2c_f32_bf16 v28, v14, v92
    v_dot2c_f32_bf16 v29, v15, v92
    v_perm_b32 v14, v111, v107, s69
    v_perm_b32 v15, v111, v107, s70
    v_dot2c_f32_bf16 v22, v14, v88
    v_dot2c_f32_bf16 v23, v15, v88
    v_dot2c_f32_bf16 v30, v14, v92
    v_dot2c_f32_bf16 v31, v15, v92
    v_perm_b32 v14, v116, v112, s69
    v_perm_b32 v15, v116, v112, s70
    v_dot2c_f32_bf16 v16, v14, v89
    v_dot2c_f32_bf16 v17, v15, v89
    v_dot2c_f32_bf16 v24, v14, v93
    v_dot2c_f32_bf16 v25, v15, v93
    v_perm_b32 v14, v117, v113, s69
    v_perm_b32 v15, v117, v113, s70
    v_dot2c_f32_bf16 v18, v14, v89
    v_dot2c_f32_bf16 v19, v15, v89
    v_dot2c_f32_bf16 v26, v14, v93
    v_dot2c_f32_bf16 v27, v15, v93
    v_perm_b32 v14, v118, v114, s69
    v_perm_b32 v15, v118, v114, s70
    v_dot2c_f32_bf16 v20, v14, v89
    v_dot2c_f32_bf16 v21, v15, v89
    v_dot2c_f32_bf16 v28, v14, v93
    v_dot2c_f32_bf16 v29, v15, v93
    v_perm_b32 v14, v119, v115, s69
    v_perm_b32 v15, v119, v115, s70
    v_dot2c_f32_bf16 v22, v14, v89
    v_dot2c_f32_bf16 v23, v15, v89
    v_dot2c_f32_bf16 v30, v14, v93
    v_dot2c_f32_bf16 v31, v15, v93
    v_perm_b32 v14, v124, v120, s69
    v_perm_b32 v15, v124, v120, s70
    v_dot2c_f32_bf16 v16, v14, v90
    v_dot2c_f32_bf16 v17, v15, v90
    v_dot2c_f32_bf16 v24, v14, v94
    v_dot2c_f32_bf16 v25, v15, v94
    v_perm_b32 v14, v125, v121, s69
    v_perm_b32 v15, v125, v121, s70
    v_dot2c_f32_bf16 v18, v14, v90
    v_dot2c_f32_bf16 v19, v15, v90
    v_dot2c_f32_bf16 v26, v14, v94
    v_dot2c_f32_bf16 v27, v15, v94
    v_perm_b32 v14, v126, v122, s69
    v_perm_b32 v15, v126, v122, s70
    v_dot2c_f32_bf16 v20, v14, v90
    v_dot2c_f32_bf16 v21, v15, v90
    v_dot2c_f32_bf16 v28, v14, v94
    v_dot2c_f32_bf16 v29, v15, v94
    v_perm_b32 v14, v127, v123, s69
    v_perm_b32 v15, v127, v123, s70
    v_dot2c_f32_bf16 v22, v14, v90
    v_dot2c_f32_bf16 v23, v15, v90
    v_dot2c_f32_bf16 v30, v14, v94
    v_dot2c_f32_bf16 v31, v15, v94
    v_perm_b32 v14, v132, v128, s69
    v_perm_b32 v15, v132, v128, s70
    v_dot2c_f32_bf16 v16, v14, v91
    v_dot2c_f32_bf16 v17, v15, v91
    v_dot2c_f32_bf16 v24, v14, v95
    v_dot2c_f32_bf16 v25, v15, v95
    v_perm_b32 v14, v133, v129, s69
    v_perm_b32 v15, v133, v129, s70
    v_dot2c_f32_bf16 v18, v14, v91
    v_dot2c_f32_bf16 v19, v15, v91
    v_dot2c_f32_bf16 v26, v14, v95
    v_dot2c_f32_bf16 v27, v15, v95
    v_perm_b32 v14, v134, v130, s69
    v_perm_b32 v15, v134, v130, s70
    v_dot2c_f32_bf16 v20, v14, v91
    v_dot2c_f32_bf16 v21, v15, v91
    v_dot2c_f32_bf16 v28, v14, v95
    v_dot2c_f32_bf16 v29, v15, v95
    v_perm_b32 v14, v135, v131, s69
    v_perm_b32 v15, v135, v131, s70
    v_dot2c_f32_bf16 v22, v14, v91
    v_dot2c_f32_bf16 v23, v15, v91
    v_dot2c_f32_bf16 v30, v14, v95
    v_dot2c_f32_bf16 v31, v15, v95
    s_nop 3
    v_lshlrev_b32 v4, 9, v2
    v_lshl_add_u32 v4, v3, 5, v4
    ds_write_b128 v4, v[16:19] offset:2048
    ds_write_b128 v4, v[20:23] offset:2064
    ds_write_b128 v4, v[24:27] offset:2304
    ds_write_b128 v4, v[28:31] offset:2320
    s_waitcnt lgkmcnt(0)
    s_barrier
    s_cmp_ge_u32 s64, 2
    s_cbranch_scc1 ffn_skip_red
    v_lshlrev_b32 v4, 2, v0
    ds_read_b32 v16, v4 offset:2048
    ds_read_b32 v17, v4 offset:2560
    ds_read_b32 v18, v4 offset:3072
    ds_read_b32 v19, v4 offset:3584
    ds_read_b32 v20, v4 offset:4096
    ds_read_b32 v21, v4 offset:4608
    ds_read_b32 v22, v4 offset:5120
    ds_read_b32 v23, v4 offset:5632
    ds_read_b32 v24, v4 offset:6144
    ds_read_b32 v25, v4 offset:6656
    ds_read_b32 v26, v4 offset:7168
    ds_read_b32 v27, v4 offset:7680
    ds_read_b32 v28, v4 offset:8192
    ds_read_b32 v29, v4 offset:8704
    ds_read_b32 v30, v4 offset:9216
    ds_read_b32 v31, v4 offset:9728
    ds_read_b32 v32, v4 offset:10240
    ds_read_b32 v33, v4 offset:10752
    ds_read_b32 v34, v4 offset:11264
    ds_read_b32 v35, v4 offset:11776
    ds_read_b32 v36, v4 offset:12288
    ds_read_b32 v37, v4 offset:12800
    ds_read_b32 v38, v4 offset:13312
    ds_read_b32 v39, v4 offset:13824
    ds_read_b32 v40, v4 offset:14336
    ds_read_b32 v41, v4 offset:14848
    ds_read_b32 v42, v4 offset:15360
    ds_read_b32 v43, v4 offset:15872
    ds_read_b32 v44, v4 offset:16384
    ds_read_b32 v45, v4 offset:16896
    ds_read_b32 v46, v4 offset:17408
    ds_read_b32 v47, v4 offset:17920
    ds_read_b32 v48, v4 offset:18432
    ds_read_b32 v49, v4 offset:18944
    ds_read_b32 v50, v4 offset:19456
    ds_read_b32 v51, v4 offset:19968
    ds_read_b32 v52, v4 offset:20480
    ds_read_b32 v53, v4 offset:20992
    ds_read_b32 v54, v4 offset:21504
    ds_read_b32 v55, v4 offset:22016
    ds_read_b32 v56, v4 offset:22528
    ds_read_b32 v57, v4 offset:23040
    ds_read_b32 v58, v4 offset:23552
    ds_read_b32 v59, v4 offset:24064
    ds_read_b32 v60, v4 offset:24576
    ds_read_b32 v61, v4 offset:25088
    ds_read_b32 v62, v4 offset:25600
    ds_read_b32 v63, v4 offset:26112
    ds_read_b32 v64, v4 offset:26624
    ds_read_b32 v65, v4 offset:27136
    ds_read_b32 v66, v4 offset:27648
    ds_read_b32 v67, v4 offset:28160
    ds_read_b32 v68, v4 offset:28672
    ds_read_b32 v69, v4 offset:29184
    ds_read_b32 v70, v4 offset:29696
    ds_read_b32 v71, v4 offset:30208
    ds_read_b32 v72, v4 offset:30720
    ds_read_b32 v73, v4 offset:31232
    ds_read_b32 v74, v4 offset:31744
    ds_read_b32 v75, v4 offset:32256
    ds_read_b32 v76, v4 offset:32768
    ds_read_b32 v77, v4 offset:33280
    ds_read_b32 v78, v4 offset:33792
    ds_read_b32 v79, v4 offset:34304
    ds_read_b32 v80, v4 offset:34816
    ds_read_b32 v81, v4 offset:35328
    ds_read_b32 v82, v4 offset:35840
    ds_read_b32 v83, v4 offset:36352
    ds_read_b32 v84, v4 offset:36864
    ds_read_b32 v85, v4 offset:37376
    ds_read_b32 v86, v4 offset:37888
    ds_read_b32 v87, v4 offset:38400
    s_waitcnt lgkmcnt(0)
    v_add_f32 v16, v16, v17
    v_add_f32 v18, v18, v19
    v_add_f32 v20, v20, v21
    v_add_f32 v22, v22, v23
    v_add_f32 v24, v24, v25
    v_add_f32 v26, v26, v27
    v_add_f32 v28, v28, v29
    v_add_f32 v30, v30, v31
    v_add_f32 v32, v32, v33
    v_add_f32 v34, v34, v35
    v_add_f32 v36, v36, v37
    v_add_f32 v38, v38, v39
    v_add_f32 v40, v40, v41
    v_add_f32 v42, v42, v43
    v_add_f32 v44, v44, v45
    v_add_f32 v46, v46, v47
    v_add_f32 v48, v48, v49
    v_add_f32 v50, v50, v51
    v_add_f32 v52, v52, v53
    v_add_f32 v54, v54, v55
    v_add_f32 v56, v56, v57
    v_add_f32 v58, v58, v59
    v_add_f32 v60, v60, v61
    v_add_f32 v62, v62, v63
    v_add_f32 v64, v64, v65
    v_add_f32 v66, v66, v67
    v_add_f32 v68, v68, v69
    v_add_f32 v70, v70, v71
    v_add_f32 v72, v72, v73
    v_add_f32 v74, v74, v75
    v_add_f32 v76, v76, v77
    v_add_f32 v78, v78, v79
    v_add_f32 v80, v80, v81
    v_add_f32 v82, v82, v83
    v_add_f32 v84, v84, v85
    v_add_f32 v86, v86, v87
    v_add_f32 v16, v16, v18
    v_add_f32 v20, v20, v22
    v_add_f32 v24, v24, v26
    v_add_f32 v28, v28, v30
    v_add_f32 v32, v32, v34
    v_add_f32 v36, v36, v38
    v_add_f32 v40, v40, v42
    v_add_f32 v44, v44, v46
    v_add_f32 v48, v48, v50
    v_add_f32 v52, v52, v54
    v_add_f32 v56, v56, v58
    v_add_f32 v60, v60, v62
    v_add_f32 v64, v64, v66
    v_add_f32 v68, v68, v70
    v_add_f32 v72, v72, v74
    v_add_f32 v76, v76, v78
    v_add_f32 v80, v80, v82
    v_add_f32 v84, v84, v86
    v_add_f32 v16, v16, v20
    v_add_f32 v24, v24, v28
    v_add_f32 v32, v32, v36
    v_add_f32 v40, v40, v44
    v_add_f32 v48, v48, v52
    v_add_f32 v56, v56, v60
    v_add_f32 v64, v64, v68
    v_add_f32 v72, v72, v76
    v_add_f32 v80, v80, v84
    v_add_f32 v16, v16, v24
    v_add_f32 v32, v32, v40
    v_add_f32 v48, v48, v56
    v_add_f32 v64, v64, v72
    v_add_f32 v16, v16, v32
    v_add_f32 v48, v48, v64
    v_add_f32 v16, v16, v48
    v_add_f32 v16, v16, v80
    v_cvt_pk_bf16_f32 v16, v16, v16
    v_lshlrev_b32 v16, 16, v16
    v_lshlrev_b32 v12, 16, v12
    v_add_f32 v16, v16, v12
    v_cvt_pk_bf16_f32 v16, v16, v16
    v_lshlrev_b32 v16, 16, v16
    v_max_f32 v16, 0, v16
    v_mul_f32 v16, v16, v16
    v_cvt_pk_bf16_f32 v16, v16, v16
    v_lshlrev_b32 v4, 1, v0
    ds_write_b16 v4, v16 offset:0
    s_waitcnt lgkmcnt(0)
ffn_skip_red:
    s_barrier
    v_lshlrev_b32 v4, 4, v10
    ds_read_b128 v[88:91], v4 offset:0
    ds_read_b128 v[92:95], v4 offset:128
    v_mov_b32 v16, 0
    v_mov_b32 v17, 0
    v_mov_b32 v18, 0
    v_mov_b32 v19, 0
    v_mov_b32 v20, 0
    v_mov_b32 v21, 0
    v_mov_b32 v22, 0
    v_mov_b32 v23, 0
    v_mov_b32 v24, 0
    v_mov_b32 v25, 0
    v_mov_b32 v26, 0
    v_mov_b32 v27, 0
    v_mov_b32 v28, 0
    v_mov_b32 v29, 0
    v_mov_b32 v30, 0
    v_mov_b32 v31, 0
    s_waitcnt vmcnt(0) lgkmcnt(0)
    v_perm_b32 v14, v140, v136, s69
    v_perm_b32 v15, v140, v136, s70
    v_dot2c_f32_bf16 v16, v14, v88
    v_dot2c_f32_bf16 v17, v15, v88
    v_dot2c_f32_bf16 v24, v14, v92
    v_dot2c_f32_bf16 v25, v15, v92
    v_perm_b32 v14, v141, v137, s69
    v_perm_b32 v15, v141, v137, s70
    v_dot2c_f32_bf16 v18, v14, v88
    v_dot2c_f32_bf16 v19, v15, v88
    v_dot2c_f32_bf16 v26, v14, v92
    v_dot2c_f32_bf16 v27, v15, v92
    v_perm_b32 v14, v142, v138, s69
    v_perm_b32 v15, v142, v138, s70
    v_dot2c_f32_bf16 v20, v14, v88
    v_dot2c_f32_bf16 v21, v15, v88
    v_dot2c_f32_bf16 v28, v14, v92
    v_dot2c_f32_bf16 v29, v15, v92
    v_perm_b32 v14, v143, v139, s69
    v_perm_b32 v15, v143, v139, s70
    v_dot2c_f32_bf16 v22, v14, v88
    v_dot2c_f32_bf16 v23, v15, v88
    v_dot2c_f32_bf16 v30, v14, v92
    v_dot2c_f32_bf16 v31, v15, v92
    v_perm_b32 v14, v148, v144, s69
    v_perm_b32 v15, v148, v144, s70
    v_dot2c_f32_bf16 v16, v14, v89
    v_dot2c_f32_bf16 v17, v15, v89
    v_dot2c_f32_bf16 v24, v14, v93
    v_dot2c_f32_bf16 v25, v15, v93
    v_perm_b32 v14, v149, v145, s69
    v_perm_b32 v15, v149, v145, s70
    v_dot2c_f32_bf16 v18, v14, v89
    v_dot2c_f32_bf16 v19, v15, v89
    v_dot2c_f32_bf16 v26, v14, v93
    v_dot2c_f32_bf16 v27, v15, v93
    v_perm_b32 v14, v150, v146, s69
    v_perm_b32 v15, v150, v146, s70
    v_dot2c_f32_bf16 v20, v14, v89
    v_dot2c_f32_bf16 v21, v15, v89
    v_dot2c_f32_bf16 v28, v14, v93
    v_dot2c_f32_bf16 v29, v15, v93
    v_perm_b32 v14, v151, v147, s69
    v_perm_b32 v15, v151, v147, s70
    v_dot2c_f32_bf16 v22, v14, v89
    v_dot2c_f32_bf16 v23, v15, v89
    v_dot2c_f32_bf16 v30, v14, v93
    v_dot2c_f32_bf16 v31, v15, v93
    v_perm_b32 v14, v156, v152, s69
    v_perm_b32 v15, v156, v152, s70
    v_dot2c_f32_bf16 v16, v14, v90
    v_dot2c_f32_bf16 v17, v15, v90
    v_dot2c_f32_bf16 v24, v14, v94
    v_dot2c_f32_bf16 v25, v15, v94
    v_perm_b32 v14, v157, v153, s69
    v_perm_b32 v15, v157, v153, s70
    v_dot2c_f32_bf16 v18, v14, v90
    v_dot2c_f32_bf16 v19, v15, v90
    v_dot2c_f32_bf16 v26, v14, v94
    v_dot2c_f32_bf16 v27, v15, v94
    v_perm_b32 v14, v158, v154, s69
    v_perm_b32 v15, v158, v154, s70
    v_dot2c_f32_bf16 v20, v14, v90
    v_dot2c_f32_bf16 v21, v15, v90
    v_dot2c_f32_bf16 v28, v14, v94
    v_dot2c_f32_bf16 v29, v15, v94
    v_perm_b32 v14, v159, v155, s69
    v_perm_b32 v15, v159, v155, s70
    v_dot2c_f32_bf16 v22, v14, v90
    v_dot2c_f32_bf16 v23, v15, v90
    v_dot2c_f32_bf16 v30, v14, v94
    v_dot2c_f32_bf16 v31, v15, v94
    v_perm_b32 v14, v164, v160, s69
    v_perm_b32 v15, v164, v160, s70
    v_dot2c_f32_bf16 v16, v14, v91
    v_dot2c_f32_bf16 v17, v15, v91
    v_dot2c_f32_bf16 v24, v14, v95
    v_dot2c_f32_bf16 v25, v15, v95
    v_perm_b32 v14, v165, v161, s69
    v_perm_b32 v15, v165, v161, s70
    v_dot2c_f32_bf16 v18, v14, v91
    v_dot2c_f32_bf16 v19, v15, v91
    v_dot2c_f32_bf16 v26, v14, v95
    v_dot2c_f32_bf16 v27, v15, v95
    v_perm_b32 v14, v166, v162, s69
    v_perm_b32 v15, v166, v162, s70
    v_dot2c_f32_bf16 v20, v14, v91
    v_dot2c_f32_bf16 v21, v15, v91
    v_dot2c_f32_bf16 v28, v14, v95
    v_dot2c_f32_bf16 v29, v15, v95
    v_perm_b32 v14, v167, v163, s69
    v_perm_b32 v15, v167, v163, s70
    v_dot2c_f32_bf16 v22, v14, v91
    v_dot2c_f32_bf16 v23, v15, v91
    v_dot2c_f32_bf16 v30, v14, v95
    v_dot2c_f32_bf16 v31, v15, v95
    s_nop 3
    v_mul_u32_u24 v4, 4608, v10
    v_lshl_add_u32 v4, v11, 5, v4
    ds_write_b128 v4, v[16:19] offset:2048
    ds_write_b128 v4, v[20:23] offset:2064
    ds_write_b128 v4, v[24:27] offset:4352
    ds_write_b128 v4, v[28:31] offset:4368
    s_waitcnt lgkmcnt(0)
    s_barrier
    v_lshlrev_b32 v4, 4, v0
    v_cmp_gt_u32 vcc, 288, v0
    s_and_saveexec_b64 s[78:79], vcc
    s_cbranch_execz ffn_st_skip
    ds_read_b128 v[16:19], v4 offset:2048
    ds_read_b128 v[20:23], v4 offset:6656
    ds_read_b128 v[24:27], v4 offset:11264
    ds_read_b128 v[28:31], v4 offset:15872
    ds_read_b128 v[32:35], v4 offset:20480
    ds_read_b128 v[36:39], v4 offset:25088
    ds_read_b128 v[40:43], v4 offset:29696
    ds_read_b128 v[44:47], v4 offset:34304
    s_waitcnt lgkmcnt(0)
    v_add_f32 v16, v16, v20
    v_add_f32 v24, v24, v28
    v_add_f32 v32, v32, v36
    v_add_f32 v40, v40, v44
    v_add_f32 v16, v16, v24
    v_add_f32 v32, v32, v40
    v_add_f32 v16, v16, v32
    v_add_f32 v17, v17, v21
    v_add_f32 v25, v25, v29
    v_add_f32 v33, v33, v37
    v_add_f32 v41, v41, v45
    v_add_f32 v17, v17, v25
    v_add_f32 v33, v33, v41
    v_add_f32 v17, v17, v33
    v_add_f32 v18, v18, v22
    v_add_f32 v26, v26, v30
    v_add_f32 v34, v34, v38
    v_add_f32 v42, v42, v46
    v_add_f32 v18, v18, v26
    v_add_f32 v34, v34, v42
    v_add_f32 v18, v18, v34
    v_add_f32 v19, v19, v23
    v_add_f32 v27, v27, v31
    v_add_f32 v35, v35, v39
    v_add_f32 v43, v43, v47
    v_add_f32 v19, v19, v27
    v_add_f32 v35, v35, v43
    v_add_f32 v19, v19, v35
    s_mul_i32 s72, s76, 4608
    s_add_u32 s72, s72, 1048576
    buffer_store_dwordx4 v[16:19], v4, s[56:59], s72 offen sc1
ffn_st_skip:
    s_mov_b64 exec, s[78:79]
    s_waitcnt vmcnt(0)
    s_barrier
ffn_done:
    s_cmp_lg_u32 s64, 8
    s_cbranch_scc1 sig_11
    s_lshl_b32 s72, s3, 2
    s_add_u32 s72, s72, 1015808
    v_mov_b32 v2, s71
    v_lshlrev_b32 v3, 10, v1
    v_cmp_gt_u32 vcc, 8, v1
    s_and_saveexec_b64 s[78:79], vcc
    buffer_store_dword v2, v3, s[56:59], s72 offen sc1
    s_mov_b64 exec, s[78:79]
sig_11:
    s_cmp_ge_u32 s75, 36
    s_cbranch_scc1 k_end
    s_cmp_ge_u32 s75, 18
    s_cselect_b32 s67, 1, 0
    s_mul_i32 s66, s67, 18
    s_sub_u32 s66, s75, s66
    s_cmp_lg_u32 s64, 4
    s_cbranch_scc1 p4_nogate
    v_mov_b32 v60, 0
    v_lshlrev_b32 v4, 5, v1
    s_mul_i32 s72, s67, 1152
    v_cmp_gt_u32 vcc, 36, v1
    s_and_saveexec_b64 s[78:79], vcc
    buffer_load_dwordx4 v[64:67], v4, s[4:7], s72 offen
    buffer_load_dwordx4 v[68:71], v4, s[4:7], s72 offen offset:16
    buffer_load_dwordx4 v[72:75], v4, s[44:47], 0 offen
    buffer_load_dwordx4 v[76:79], v4, s[44:47], 0 offen offset:16
    s_waitcnt vmcnt(0)
    v_lshlrev_b32 v61, 16, v64
    v_lshlrev_b32 v62, 16, v72
    v_mul_f32 v61, v61, v62
    v_cvt_pk_bf16_f32 v61, v61, v61
    v_lshlrev_b32 v61, 16, v61
    v_add_f32 v60, v60, v61
    v_and_b32 v61, 0xffff0000, v64
    v_and_b32 v62, 0xffff0000, v72
    v_mul_f32 v61, v61, v62
    v_cvt_pk_bf16_f32 v61, v61, v61
    v_lshlrev_b32 v61, 16, v61
    v_add_f32 v60, v60, v61
    v_lshlrev_b32 v61, 16, v65
    v_lshlrev_b32 v62, 16, v73
    v_mul_f32 v61, v61, v62
    v_cvt_pk_bf16_f32 v61, v61, v61
    v_lshlrev_b32 v61, 16, v61
    v_add_f32 v60, v60, v61
    v_and_b32 v61, 0xffff0000, v65
    v_and_b32 v62, 0xffff0000, v73
    v_mul_f32 v61, v61, v62
    v_cvt_pk_bf16_f32 v61, v61, v61
    v_lshlrev_b32 v61, 16, v61
    v_add_f32 v60, v60, v61
    v_lshlrev_b32 v61, 16, v66
    v_lshlrev_b32 v62, 16, v74
    v_mul_f32 v61, v61, v62
    v_cvt_pk_bf16_f32 v61, v61, v61
    v_lshlrev_b32 v61, 16, v61
    v_add_f32 v60, v60, v61
    v_and_b32 v61, 0xffff0000, v66
    v_and_b32 v62, 0xffff0000, v74
    v_mul_f32 v61, v61, v62
    v_cvt_pk_bf16_f32 v61, v61, v61
    v_lshlrev_b32 v61, 16, v61
    v_add_f32 v60, v60, v61
    v_lshlrev_b32 v61, 16, v67
    v_lshlrev_b32 v62, 16, v75
    v_mul_f32 v61, v61, v62
    v_cvt_pk_bf16_f32 v61, v61, v61
    v_lshlrev_b32 v61, 16, v61
    v_add_f32 v60, v60, v61
    v_and_b32 v61, 0xffff0000, v67
    v_and_b32 v62, 0xffff0000, v75
    v_mul_f32 v61, v61, v62
    v_cvt_pk_bf16_f32 v61, v61, v61
    v_lshlrev_b32 v61, 16, v61
    v_add_f32 v60, v60, v61
    v_lshlrev_b32 v61, 16, v68
    v_lshlrev_b32 v62, 16, v76
    v_mul_f32 v61, v61, v62
    v_cvt_pk_bf16_f32 v61, v61, v61
    v_lshlrev_b32 v61, 16, v61
    v_add_f32 v60, v60, v61
    v_and_b32 v61, 0xffff0000, v68
    v_and_b32 v62, 0xffff0000, v76
    v_mul_f32 v61, v61, v62
    v_cvt_pk_bf16_f32 v61, v61, v61
    v_lshlrev_b32 v61, 16, v61
    v_add_f32 v60, v60, v61
    v_lshlrev_b32 v61, 16, v69
    v_lshlrev_b32 v62, 16, v77
    v_mul_f32 v61, v61, v62
    v_cvt_pk_bf16_f32 v61, v61, v61
    v_lshlrev_b32 v61, 16, v61
    v_add_f32 v60, v60, v61
    v_and_b32 v61, 0xffff0000, v69
    v_and_b32 v62, 0xffff0000, v77
    v_mul_f32 v61, v61, v62
    v_cvt_pk_bf16_f32 v61, v61, v61
    v_lshlrev_b32 v61, 16, v61
    v_add_f32 v60, v60, v61
    v_lshlrev_b32 v61, 16, v70
    v_lshlrev_b32 v62, 16, v78
    v_mul_f32 v61, v61, v62
    v_cvt_pk_bf16_f32 v61, v61, v61
    v_lshlrev_b32 v61, 16, v61
    v_add_f32 v60, v60, v61
    v_and_b32 v61, 0xffff0000, v70
    v_and_b32 v62, 0xffff0000, v78
    v_mul_f32 v61, v61, v62
    v_cvt_pk_bf16_f32 v61, v61, v61
    v_lshlrev_b32 v61, 16, v61
    v_add_f32 v60, v60, v61
    v_lshlrev_b32 v61, 16, v71
    v_lshlrev_b32 v62, 16, v79
    v_mul_f32 v61, v61, v62
    v_cvt_pk_bf16_f32 v61, v61, v61
    v_lshlrev_b32 v61, 16, v61
    v_add_f32 v60, v60, v61
    v_and_b32 v61, 0xffff0000, v71
    v_and_b32 v62, 0xffff0000, v79
    v_mul_f32 v61, v61, v62
    v_cvt_pk_bf16_f32 v61, v61, v61
    v_lshlrev_b32 v61, 16, v61
    v_add_f32 v60, v60, v61
    s_mov_b64 exec, s[78:79]
    s_nop 1
    v_add_f32_dpp v60, v60, v60 quad_perm:[1,0,3,2] row_mask:0xf bank_mask:0xf
    s_nop 1
    v_add_f32_dpp v60, v60, v60 quad_perm:[2,3,0,1] row_mask:0xf bank_mask:0xf
    s_nop 1
    v_add_f32_dpp v60, v60, v60 row_half_mirror row_mask:0xf bank_mask:0xf
    s_nop 1
    v_add_f32_dpp v60, v60, v60 row_mirror row_mask:0xf bank_mask:0xf
    v_mov_b32 v61, v60
    s_nop 1
    v_permlane16_swap_b32 v60, v61
    s_nop 1
    v_add_f32 v60, v60, v61
    v_mov_b32 v61, v60
    s_nop 1
    v_permlane32_swap_b32 v60, v61
    s_nop 1
    v_add_f32 v60, v60, v61
    v_cvt_pk_bf16_f32 v60, v60, v60
    v_lshlrev_b32 v60, 16, v60
    v_mul_f32 v60, 3216550459, v60
    v_exp_f32 v60, v60
    s_nop 0
    v_add_f32 v60, 1.0, v60
    v_rcp_f32 v60, v60
    s_nop 0
    v_cvt_pk_bf16_f32 v60, v60, v60
    v_lshlrev_b32 v60, 16, v60
    v_mov_b32 v4, 0
    ds_write_b32 v4, v60 offset:65280
    s_waitcnt lgkmcnt(0)
p4_nogate:
    s_cmp_lg_u32 s64, 8
    s_cbranch_scc1 p4_nn
    v_mov_b32 v4, 0
    v_mov_b32 v5, s71
    ds_write_b32 v4, v5 offset:65296
    s_waitcnt lgkmcnt(0)
    p4_nn:
    v_and_b32 v62, 31, v1
    v_lshlrev_b32 v62, 1, v62
    s_lshl_b32 s73, s66, 6
    buffer_load_ushort v63, v62, s[40:43], s73 offen
    s_cmp_lg_u32 s64, 8
    s_cbranch_scc1 poll_12_done
    v_and_b32 v2, 31, v1
    v_lshlrev_b32 v2, 4, v2
    s_and_b32 s72, s2, 7
    s_lshl_b32 s72, s72, 10
    s_add_u32 s72, s72, 1015808
    s_mov_b32 s77, 0
poll_12_loop:
    buffer_load_dwordx4 v[12:15], v2, s[56:59], s72 offen sc1
    s_add_u32 s77, s77, 1
    s_waitcnt vmcnt(0)
    v_xor_b32 v12, s71, v12
    v_xor_b32 v13, s71, v13
    v_xor_b32 v14, s71, v14
    v_xor_b32 v15, s71, v15
    v_or3_b32 v12, v12, v13, v14
    v_or_b32 v12, v12, v15
    v_cmp_ne_u32 vcc, 0, v12
    s_cmp_ge_u32 s77, 200000
    s_cbranch_scc1 poll_12_done
    s_cbranch_vccnz poll_12_loop
poll_12_done:
    s_barrier
    s_cmp_ge_u32 s64, 8
    s_cbranch_scc1 p4_ld_skip
    v_mov_b32 v4, 0
    ds_read_b32 v5, v4 offset:65296
    v_lshrrev_b32 v2, 3, v0
    v_and_b32 v3, 7, v0
    v_mul_u32_u24 v4, 4608, v2
    v_lshl_add_u32 v4, v3, 4, v4
    s_mul_i32 s72, s67, 2304
    s_lshl_b32 s73, s66, 7
    s_add_u32 s72, s72, s73
    buffer_load_dwordx4 v[48:51], v4, s[60:63], s72 offen sc1
    s_add_u32 s72, s72, 294912
    buffer_load_dwordx4 v[52:55], v4, s[60:63], s72 offen sc1
    s_add_u32 s72, s72, 294912
    v_lshrrev_b32 v6, 4, v0
    v_and_b32 v7, 15, v0
    v_mul_u32_u24 v9, 9216, v6
    v_lshl_add_u32 v9, v7, 4, v9
    s_mul_i32 s72, s67, 4608
    s_lshl_b32 s73, s66, 8
    s_add_u32 s72, s72, s73
    s_add_u32 s72, s72, 2097152
    s_mov_b32 s77, 0
    s_waitcnt lgkmcnt(0)
e3v_retry:
    s_mov_b32 s74, s72
    buffer_load_dwordx4 v[16:19], v9, s[56:59], s74 offen sc1
    s_add_u32 s74, s74, 294912
    buffer_load_dwordx4 v[20:23], v9, s[56:59], s74 offen sc1
    s_add_u32 s74, s74, 294912
    buffer_load_dwordx4 v[24:27], v9, s[56:59], s74 offen sc1
    s_add_u32 s74, s74, 294912
    buffer_load_dwordx4 v[28:31], v9, s[56:59], s74 offen sc1
    s_add_u32 s74, s74, 294912
    s_waitcnt vmcnt(0)
    v_xor_b32 v17, v17, v5
    v_xor_b32 v19, v19, v5
    v_xor_b32 v21, v21, v5
    v_xor_b32 v23, v23, v5
    v_xor_b32 v25, v25, v5
    v_xor_b32 v27, v27, v5
    v_xor_b32 v29, v29, v5
    v_xor_b32 v31, v31, v5
    v_or3_b32 v17, v17, v19, v21
    v_or3_b32 v23, v23, v25, v27
    v_or3_b32 v17, v17, v29, v31
    v_or_b32 v17, v17, v23
    v_cmp_ne_u32 vcc, 0, v17
    s_add_u32 s77, s77, 1
    s_cmp_ge_u32 s77, 200000
    s_cbranch_scc1 e3v_ok
    s_cbranch_vccnz e3v_retry
e3v_ok:
    v_add_f32 v16, v16, v20
    v_add_f32 v24, v24, v28
    v_add_f32 v16, v16, v24
    v_add_f32 v18, v18, v22
    v_add_f32 v26, v26, v30
    v_add_f32 v17, v18, v26
    v_add_f32 v48, v48, v52
    v_add_f32 v49, v49, v53
    v_add_f32 v50, v50, v54
    v_add_f32 v51, v51, v55
    s_nop 1
    v_add_f32_dpp v48, v48, v48 row_ror:8 row_mask:0xf bank_mask:0xf
    v_add_f32_dpp v49, v49, v49 row_ror:8 row_mask:0xf bank_mask:0xf
    v_add_f32_dpp v50, v50, v50 row_ror:8 row_mask:0xf bank_mask:0xf
    v_add_f32_dpp v51, v51, v51 row_ror:8 row_mask:0xf bank_mask:0xf
    v_mov_b32 v20, v16
    v_mov_b32 v21, v17
    v_mov_b32 v22, v48
    v_mov_b32 v23, v49
    v_mov_b32 v24, v50
    v_mov_b32 v25, v51
    s_nop 1
    v_permlane16_swap_b32 v16, v20
    v_permlane16_swap_b32 v17, v21
    v_permlane16_swap_b32 v48, v22
    v_permlane16_swap_b32 v49, v23
    v_permlane16_swap_b32 v50, v24
    v_permlane16_swap_b32 v51, v25
    s_nop 1
    v_add_f32 v16, v16, v20
    v_add_f32 v17, v17, v21
    v_add_f32 v48, v48, v22
    v_add_f32 v49, v49, v23
    v_add_f32 v50, v50, v24
    v_add_f32 v51, v51, v25
    v_mov_b32 v20, v16
    v_mov_b32 v21, v17
    v_mov_b32 v22, v48
    v_mov_b32 v23, v49
    v_mov_b32 v24, v50
    v_mov_b32 v25, v51
    s_nop 1
    v_permlane32_swap_b32 v16, v20
    v_permlane32_swap_b32 v17, v21
    v_permlane32_swap_b32 v48, v22
    v_permlane32_swap_b32 v49, v23
    v_permlane32_swap_b32 v50, v24
    v_permlane32_swap_b32 v51, v25
    s_nop 1
    v_add_f32 v16, v16, v20
    v_add_f32 v17, v17, v21
    v_add_f32 v48, v48, v22
    v_add_f32 v49, v49, v23
    v_add_f32 v50, v50, v24
    v_add_f32 v51, v51, v25
    s_lshl_b32 s74, s64, 7
    v_lshlrev_b32 v4, 3, v7
    v_add_u32 v4, s74, v4
    ds_write_b64 v4, v[16:17] offset:40960
    v_lshlrev_b32 v4, 4, v3
    v_add_u32 v4, s74, v4
    ds_write_b128 v4, v[48:51] offset:49152
    s_waitcnt lgkmcnt(0)
p4_ld_skip:
    s_barrier
    s_cmp_lg_u32 s64, 0
    s_cbranch_scc1 p4_end
    v_and_b32 v4, 31, v1
    v_lshlrev_b32 v4, 2, v4
    v_mov_b32 v3, 0
    ds_read_b32 v16, v4 offset:40960
    ds_read_b32 v17, v4 offset:41088
    ds_read_b32 v18, v4 offset:41216
    ds_read_b32 v19, v4 offset:41344
    ds_read_b32 v20, v4 offset:41472
    ds_read_b32 v21, v4 offset:41600
    ds_read_b32 v22, v4 offset:41728
    ds_read_b32 v23, v4 offset:41856
    ds_read_b32 v64, v4 offset:49152
    ds_read_b32 v65, v4 offset:49280
    ds_read_b32 v66, v4 offset:49408
    ds_read_b32 v67, v4 offset:49536
    ds_read_b32 v68, v4 offset:49664
    ds_read_b32 v69, v4 offset:49792
    ds_read_b32 v70, v4 offset:49920
    ds_read_b32 v71, v4 offset:50048
    ds_read_b32 v60, v3 offset:65280
    v_mov_b32 v7, v62
    s_lshl_b32 s73, s66, 6
    s_waitcnt lgkmcnt(0)
    v_add_f32 v16, v16, v17
    v_add_f32 v18, v18, v19
    v_add_f32 v20, v20, v21
    v_add_f32 v22, v22, v23
    v_add_f32 v16, v16, v18
    v_add_f32 v20, v20, v22
    v_add_f32 v16, v16, v20
    v_add_f32 v64, v64, v65
    v_add_f32 v66, v66, v67
    v_add_f32 v68, v68, v69
    v_add_f32 v70, v70, v71
    v_add_f32 v64, v64, v66
    v_add_f32 v68, v68, v70
    v_add_f32 v64, v64, v68
    v_cvt_pk_bf16_f32 v16, v16, v16
    v_lshlrev_b32 v16, 16, v16
    v_mov_b32 v17, v64
    v_cvt_pk_bf16_f32 v17, v17, v17
    v_lshlrev_b32 v17, 16, v17
    v_lshlrev_b32 v8, 16, v63
    v_add_f32 v17, v17, v8
    v_cvt_pk_bf16_f32 v17, v17, v17
    v_lshlrev_b32 v17, 16, v17
    v_mul_f32 v16, v60, v16
    v_cvt_pk_bf16_f32 v16, v16, v16
    v_lshlrev_b32 v16, 16, v16
    v_sub_f32 v18, 1.0, v60
    v_cvt_pk_bf16_f32 v18, v18, v18
    v_lshlrev_b32 v18, 16, v18
    v_mul_f32 v17, v18, v17
    v_cvt_pk_bf16_f32 v17, v17, v17
    v_lshlrev_b32 v17, 16, v17
    v_add_f32 v16, v16, v17
    v_cvt_pk_bf16_f32 v16, v16, v16
    s_mul_i32 s72, s67, 1152
    s_add_u32 s72, s72, s73
    v_cmp_gt_u32 vcc, 32, v1
    s_and_saveexec_b64 s[78:79], vcc
    buffer_store_short v16, v7, s[48:51], s72 offen
    s_mov_b64 exec, s[78:79]
p4_end:
k_end:
    s_endpgm
.section .rodata,"a"
.p2align 6
.amdhsa_kernel gated_mix__compressed_kv_cla__dense_activation_squared_relu__decode_kernel
  .amdhsa_next_free_vgpr 168
  .amdhsa_next_free_sgpr 102
  .amdhsa_accum_offset 168
  .amdhsa_group_segment_fixed_size 0
  .amdhsa_kernarg_size 120
  .amdhsa_user_sgpr_count 2
  .amdhsa_user_sgpr_kernarg_segment_ptr 1
  .amdhsa_system_sgpr_workgroup_id_x 1
.end_amdhsa_kernel
```
